```python
import torch

def _softmax(x, axis=-1):
    return torch.softmax(x, dim=axis)

def _gelu(x):
    return torch.nn.functional.gelu(x, approximate='tanh')

def _silu(x):
    return torch.nn.functional.silu(x)

def _sigmoid(x):
    return torch.sigmoid(x)

def _layernorm(x, axis=-1, eps=1e-05):
    m = x.mean(dim=axis, keepdim=True)
    v = x.var(dim=axis, keepdim=True, unbiased=False)
    return (x - m) / torch.sqrt(v + eps)

def _scatter_add(tgt, idx, src, axis=0):
    return tgt.clone().index_add_(axis, idx, src)

def _segment_sum(src, seg, n):
    out = torch.zeros((n,) + src.shape[1:], dtype=src.dtype)
    return out.index_add_(0, seg, src)

def _pad(x, pw):
    flat = tuple((v for pair in reversed(pw) for v in pair))
    return torch.nn.functional.pad(x, flat)
kernel_name = 'adaLN_cond__ssm_conv_h3__geglu_ffn__prompt'

def setup_inputs():

    _w = lambda a: (lambda t: t.to(torch.bfloat16) if t.is_floating_point() else t)(torch.as_tensor(a))

    def _A_setup():
        B, S, D = (1, 2048, 512)
        ks = 4
        return {'q': _w((lambda *s: torch.randn(*s, dtype=torch.bfloat16) * 0.05)(B, S, D)), 'k': _w((lambda *s: torch.randn(*s, dtype=torch.bfloat16) * 0.8)(B, S, D)), 'v': _w((lambda *s: torch.randn(*s, dtype=torch.bfloat16) * 0.8)(B, S, D)), 'shift_k': _w((lambda *s: torch.randn(*s, dtype=torch.bfloat16) * 0.8)(D, ks) * 0.5), 'ssm_k': _w((lambda *s: torch.randn(*s, dtype=torch.bfloat16) * 0.8)(D, S) * (1.0 / S ** 0.5)), 'ssm_D': _w((lambda *s: torch.randn(*s, dtype=torch.bfloat16) * 0.8)(D))}
    _A_in = _A_setup()

    def _B_setup():
        B, S, D, F = (1, 2048, 512, 1792)
        return {'x': _w((lambda *s: torch.randn(*s, dtype=torch.bfloat16) * 0.05)(B, S, D)), 'w_gate': _w((lambda *s: torch.randn(*s, dtype=torch.bfloat16) * 0.05)(D, F)), 'w_up': _w((lambda *s: torch.randn(*s, dtype=torch.bfloat16) * 0.05)(D, F)), 'w_down': _w((lambda *s: torch.randn(*s, dtype=torch.bfloat16) * 0.05)(F, D))}
    _B_in = _B_setup()
    return {'A_q': _A_in['q'], 'A_k': _A_in['k'], 'A_v': _A_in['v'], 'A_shift_k': _A_in['shift_k'], 'A_ssm_k': _A_in['ssm_k'], 'A_ssm_D': _A_in['ssm_D'], 'B_x': _B_in['x'], 'B_w_gate': _B_in['w_gate'], 'B_w_up': _B_in['w_up'], 'B_w_down': _B_in['w_down'], 'c': _w((lambda *s: torch.randn(*s, dtype=torch.bfloat16) * 0.1)(1, 512) * 8.0), 'w_mod': _w((lambda *s: torch.randn(*s, dtype=torch.bfloat16) * 0.1)(512, 6 * 512) * 512 ** (-0.5) * 8.0)}

def reference(A_q, A_k, A_v, A_shift_k, A_ssm_k, A_ssm_D, B_x, B_w_gate, B_w_up, B_w_down, c, w_mod):

    def _A_ref(q, k, v, shift_k, ssm_k, ssm_D):
        B, S, D = q.shape
        ks = shift_k.shape[-1]
        k_pad = _pad(k, ((0, 0), (ks - 1, 0), (0, 0)))
        k_shift = torch.zeros_like(k)
        for t in range(ks):
            k_shift = k_shift + k_pad[:, t:t + S, :] * shift_k[:, ks - 1 - t][None, None, :]
        kv = k_shift * v
        L = 2 * S
        kv_pad = _pad(kv, ((0, 0), (0, S), (0, 0)))
        kf_pad = _pad(ssm_k, ((0, 0), (0, S)))
        kv_f = (lambda x, axes=(-2, -1): torch.fft.rfft2(x.float(), dim=axes))(kv_pad[:, None, :, :], axes=(1, 2))
        kf_f = (lambda x, axes=(-2, -1): torch.fft.rfft2(x.float(), dim=axes))(kf_pad[:, None, :], axes=(1, 2))
        kf_f = (lambda x, *d: x.permute(*d))(kf_f, 1, 2, 0)
        y_f = kv_f * kf_f[None, :, :, :]
        y = (lambda x, s, axes=(-2, -1): torch.fft.irfft2(x, s=s, dim=axes).to(torch.bfloat16))(y_f, (1, L), axes=(1, 2))[:, 0, :S, :]
        y = y + kv * ssm_D[None, None, :]
        return q * y

    def _B_ref(x, w_gate, w_up, w_down):
        return _gelu(x @ w_gate) * (x @ w_up) @ w_down
    x = A_q
    mod = (_silu(c) @ w_mod).reshape(c.shape[0], 6, 1, -1)
    sa, ca, ga, sb, cb, gb = (mod[:, 0].clone(), mod[:, 1].clone(), mod[:, 2].clone(), mod[:, 3].clone(), mod[:, 4].clone(), mod[:, 5].clone())
    h = _layernorm(x, axis=-1) * (1 + ca) + sa
    x = x + ga * _A_ref(h, A_k, A_v, A_shift_k, A_ssm_k, A_ssm_D)
    h = _layernorm(x, axis=-1) * (1 + cb) + sb
    x = x + gb * _B_ref(h, B_w_gate, B_w_up, B_w_down)
    return x
```

```asm
; @launch grid=(256,1,1) block=(512,1,1) lds=160256
.amdgcn_target "amdgcn-amd-amdhsa--gfx950"
.text
.globl adaLN_cond__ssm_conv_h3__geglu_ffn__prompt_kernel
.p2align 8
.type adaLN_cond__ssm_conv_h3__geglu_ffn__prompt_kernel,@function
adaLN_cond__ssm_conv_h3__geglu_ffn__prompt_kernel:
    s_cmp_ge_u32 s2, 256
    s_cbranch_scc1 L_end
    s_load_dwordx16 s[16:31], s[0:1], 0
    s_load_dwordx8 s[32:39], s[0:1], 64
    s_load_dwordx4 s[12:15], s[0:1], 96
    s_load_dwordx2 s[4:5], s[0:1], 112
    v_lshrrev_b32 v2, 6, v0
    v_and_b32 v1, 63, v0
    v_readfirstlane_b32 s3, v2
    s_and_b32 s6, s2, 7
    s_lshr_b32 s7, s2, 3
    s_and_b32 s8, s6, 1
    s_lshl_b32 s8, s8, 3
    s_and_b32 s60, s7, 7
    s_add_u32 s8, s8, s60
    s_lshr_b32 s9, s6, 1
    s_lshl_b32 s9, s9, 2
    s_lshr_b32 s60, s7, 3
    s_add_u32 s9, s9, s60
    s_mov_b32 s10, 0xffff0000
    v_mov_b32 v3, 0x24000
    v_lshlrev_b32 v4, 4, v1
    v_mov_b32 v5, 1
    s_cmp_lt_u32 s3, 6
    s_cbranch_scc1 Lip_1
    s_getpc_b64 s[60:61]
    s_and_b32 s60, s60, 0xffffff00
    s_lshl_b32 s62, s7, 1
    s_add_u32 s62, s62, s3
    s_sub_u32 s62, s62, 6
    s_lshl_b32 s62, s62, 10
    v_add_u32 v6, s62, v4
    v_cmp_gt_u32 vcc, L_end-adaLN_cond__ssm_conv_h3__geglu_ffn__prompt_kernel-16, v6
    s_mov_b64 exec, vcc
    s_cbranch_execz Lip_2
    global_load_dwordx4 v[120:123], v6, s[60:61]
Lip_2:
    s_mov_b64 exec, -1
Lip_1:
    v_mov_b32 v96, 0
    v_mov_b32 v97, 0
    v_mov_b32 v98, 0
    v_mov_b32 v99, 0
    s_lshr_b32 s60, s3, 1
    s_mul_i32 s60, s60, 25856
    s_and_b32 s61, s3, 1
    s_mul_i32 s61, s61, 4576
    s_add_u32 s60, s60, s61
    s_add_u32 s60, s60, 20736
    s_cmp_lt_u32 s3, 4
    s_cselect_b32 s60, s60, 0x24000
    s_cselect_b32 s61, 28, 16
    v_add_u32 v14, s60, v4
    v_cmp_gt_u32 vcc, s61, v1
    s_mov_b64 exec, vcc
    ds_write_b128 v14, v[96:99]
    s_mov_b64 exec, -1
    s_waitcnt lgkmcnt(0)
    v_mov_b32 v6, 0x12dc000
    global_load_dword v127, v6, s[4:5] sc1
    s_barrier
    s_cmp_ge_u32 s3, 4
    s_cbranch_scc1 L_b
    s_setprio 1
    s_mov_b32 s78, s6
    s_mov_b32 s79, s7
    v_lshrrev_b32 v8, 3, v1
    v_and_b32 v9, 7, v1
    s_lshl_b32 s60, s78, 6
    s_lshl_b32 s61, s3, 4
    s_add_u32 s60, s60, s61
    v_lshl_add_u32 v10, v9, 1, s60
    s_lshl_b32 s61, s3, 1
    v_xor_b32 v11, s61, v9
    v_lshlrev_b32 v11, 4, v11
    v_lshl_add_u32 v11, v8, 10, v11
    s_lshl_b32 s61, s79, 16
    s_lshl_b32 s62, s78, 7
    s_add_u32 s61, s61, s62
    v_add_u32 v11, s61, v11
    v_add_u32 v12, 0xffffe000, v11
    s_lshl_b32 s62, s3, 13
    s_add_u32 s63, s62, 32768
    s_lshl_b32 s64, s3, 10
    v_lshlrev_b32 v13, 3, v10
    s_mov_b32 s40, s18
    s_mov_b32 s41, s19
    s_mov_b32 s42, 0x200000
    s_mov_b32 s43, 0x20000
    s_cmp_lg_u32 s3, 3
    s_cbranch_scc1 Lh_3
    s_mov_b32 m0, 69632
    s_nop 0
    buffer_load_dwordx4 v12, s[40:43], 0 offen lds
Lh_3:
    s_add_u32 m0, s64, 70656
    s_nop 0
    buffer_load_dwordx4 v11, s[40:43], s62 offen lds
    s_add_u32 m0, s64, 74752
    s_nop 0
    buffer_load_dwordx4 v11, s[40:43], s63 offen lds
    s_mov_b32 s48, s20
    s_mov_b32 s49, s21
    s_mov_b32 s50, 0x200000
    s_mov_b32 s51, 0x20000
    s_add_u32 m0, s64, 78848
    s_nop 0
    buffer_load_dwordx4 v11, s[48:51], s62 offen lds
    s_add_u32 m0, s64, 82944
    s_nop 0
    buffer_load_dwordx4 v11, s[48:51], s63 offen lds
    s_mov_b32 s44, s22
    s_mov_b32 s45, s23
    s_mov_b32 s46, 0x1000
    s_mov_b32 s47, 0x20000
    buffer_load_dwordx4 v[44:47], v13, s[44:47], 0 offen
    s_mov_b32 s52, s16
    s_mov_b32 s53, s17
    s_mov_b32 s54, 0x200000
    s_mov_b32 s55, 0x20000
    s_add_u32 m0, s64, 87040
    s_nop 0
    buffer_load_dwordx4 v11, s[52:55], s62 offen lds
    s_add_u32 m0, s64, 91136
    s_nop 0
    buffer_load_dwordx4 v11, s[52:55], s63 offen lds
    v_lshrrev_b32 v11, 2, v9
    s_lshl_b32 s61, s3, 1
    v_add_u32 v11, s61, v11
    v_and_b32 v12, 3, v8
    v_lshlrev_b32 v12, 1, v12
    v_xor_b32 v12, v12, v11
    v_add_u32 v13, 3, v8
    v_and_b32 v13, 3, v13
    v_lshlrev_b32 v13, 1, v13
    v_xor_b32 v13, v13, v11
    v_and_b32 v11, 3, v9
    v_lshlrev_b32 v11, 2, v11
    v_lshl_add_u32 v11, v8, 10, v11
    v_add_u32 v11, 0x11000, v11
    v_lshl_add_u32 v12, v12, 4, v11
    v_lshl_add_u32 v13, v13, 4, v11
    s_lshr_b32 s68, s3, 1
    s_and_b32 s69, s3, 1
    s_lshl_b32 s70, s6, 6
    s_lshl_b32 s60, s7, 1
    s_add_u32 s70, s70, s60
    s_add_u32 s70, s70, s68
    s_mul_i32 s71, s68, 25856
    s_mul_i32 s72, s69, 4576
    s_add_u32 s72, s72, s71
    s_add_u32 s72, s72, 16640
    s_lshl_b32 s73, s70, 12
    s_waitcnt vmcnt(7)
    v_readfirstlane_b32 s100, v127
    s_add_u32 s100, s100, 0x9e3779b9
    s_mov_b32 s101, s100
    s_waitcnt vmcnt(3)
    s_mov_b64 exec, 1
    ds_add_rtn_u32 v6, v3, v5 offset:96
    s_mov_b64 exec, -1
    s_mov_b32 s66, 0
Lsp_5:
    ds_read_b32 v6, v3 offset:96
    s_add_u32 s66, s66, 1
    s_cmp_gt_u32 s66, 8000000
    s_waitcnt lgkmcnt(0)
    s_cbranch_scc1 Lsd_6
    v_readfirstlane_b32 s11, v6
    s_cmp_ge_u32 s11, 4
    s_cbranch_scc0 Lsp_5
Lsd_6:
    ds_read_b32 v16, v13 offset:640
    ds_read_b32 v17, v13 offset:768
    ds_read_b32 v18, v13 offset:896
    ds_read_b32 v19, v12 offset:1024
    ds_read_b32 v20, v12 offset:1152
    ds_read_b32 v21, v12 offset:1280
    ds_read_b32 v22, v12 offset:1408
    ds_read_b32 v23, v12 offset:1536
    ds_read_b32 v24, v12 offset:1664
    ds_read_b32 v25, v12 offset:1792
    ds_read_b32 v26, v12 offset:1920
    ds_read_b32 v27, v12 offset:9216
    ds_read_b32 v28, v12 offset:9344
    ds_read_b32 v29, v12 offset:9472
    ds_read_b32 v30, v12 offset:9600
    ds_read_b32 v31, v12 offset:9728
    ds_read_b32 v32, v12 offset:9856
    ds_read_b32 v33, v12 offset:9984
    ds_read_b32 v34, v12 offset:10112
    s_mov_b32 s40, s4
    s_mov_b32 s41, s5
    s_mov_b32 s42, 0x210000
    s_mov_b32 s43, 0x20000
    s_add_u32 s44, s4, 0x210000
    s_addc_u32 s45, s5, 0
    s_mov_b32 s46, 0x200000
    s_mov_b32 s47, 0x20000
    s_waitcnt vmcnt(2)
    v_lshlrev_b32 v48, 16, v44
    v_lshlrev_b32 v49, 16, v46
    v_and_b32 v50, s10, v44
    v_and_b32 v51, s10, v46
    v_lshlrev_b32 v52, 16, v45
    v_lshlrev_b32 v53, 16, v47
    v_and_b32 v54, s10, v45
    v_and_b32 v55, s10, v47
    s_waitcnt lgkmcnt(15)
    v_lshlrev_b32 v56, 16, v16
    v_and_b32 v57, s10, v16
    v_lshlrev_b32 v58, 16, v17
    v_and_b32 v59, s10, v17
    v_lshlrev_b32 v60, 16, v18
    v_and_b32 v61, s10, v18
    v_lshlrev_b32 v62, 16, v19
    v_and_b32 v63, s10, v19
    s_waitcnt lgkmcnt(14)
    v_lshlrev_b32 v64, 16, v20
    v_and_b32 v65, s10, v20
    s_waitcnt lgkmcnt(13)
    v_lshlrev_b32 v66, 16, v21
    v_and_b32 v67, s10, v21
    s_waitcnt lgkmcnt(12)
    v_lshlrev_b32 v68, 16, v22
    v_and_b32 v69, s10, v22
    s_waitcnt lgkmcnt(11)
    v_lshlrev_b32 v70, 16, v23
    v_and_b32 v71, s10, v23
    s_waitcnt lgkmcnt(10)
    v_lshlrev_b32 v72, 16, v24
    v_and_b32 v73, s10, v24
    s_waitcnt lgkmcnt(9)
    v_lshlrev_b32 v74, 16, v25
    v_and_b32 v75, s10, v25
    s_waitcnt lgkmcnt(8)
    v_lshlrev_b32 v76, 16, v26
    v_and_b32 v77, s10, v26
    v_mul_u32_u24 v14, 4224, v10
    v_lshlrev_b32 v15, 4, v8
    v_sub_u32 v15, v14, v15
    s_lshl_b32 s60, s79, 7
    s_sub_u32 s60, 4080, s60
    v_add_u32 v15, s60, v15
    s_mov_b32 s62, 4224
    s_cmp_lg_u32 s79, 0
    s_cbranch_scc1 Lpad_7
    v_mov_b32 v112, 0
    v_mov_b32 v113, 0
    v_mov_b32 v114, 0
    v_mov_b32 v115, 0
    v_lshl_add_u32 v14, v8, 4, v14
    v_add_u32 v14, 4096, v14
    s_mov_b32 exec_hi, 0
    buffer_store_dwordx4 v[112:115], v14, s[40:43], 0 offen sc1
    buffer_store_dwordx4 v[112:115], v14, s[40:43], s62 offen sc1
    s_mov_b64 exec, -1
Lpad_7:
    v_pk_mul_f32 v[78:79], v[62:63], v[48:49]
    v_pk_fma_f32 v[78:79], v[60:61], v[50:51], v[78:79]
    v_pk_fma_f32 v[78:79], v[58:59], v[52:53], v[78:79]
    v_pk_fma_f32 v[78:79], v[56:57], v[54:55], v[78:79]
    v_pk_mul_f32 v[80:81], v[64:65], v[48:49]
    v_pk_fma_f32 v[80:81], v[62:63], v[50:51], v[80:81]
    v_pk_fma_f32 v[80:81], v[60:61], v[52:53], v[80:81]
    v_pk_fma_f32 v[80:81], v[58:59], v[54:55], v[80:81]
    v_pk_mul_f32 v[82:83], v[66:67], v[48:49]
    v_pk_fma_f32 v[82:83], v[64:65], v[50:51], v[82:83]
    v_pk_fma_f32 v[82:83], v[62:63], v[52:53], v[82:83]
    v_pk_fma_f32 v[82:83], v[60:61], v[54:55], v[82:83]
    v_pk_mul_f32 v[84:85], v[68:69], v[48:49]
    v_pk_fma_f32 v[84:85], v[66:67], v[50:51], v[84:85]
    v_pk_fma_f32 v[84:85], v[64:65], v[52:53], v[84:85]
    v_pk_fma_f32 v[84:85], v[62:63], v[54:55], v[84:85]
    v_pk_mul_f32 v[86:87], v[70:71], v[48:49]
    v_pk_fma_f32 v[86:87], v[68:69], v[50:51], v[86:87]
    v_pk_fma_f32 v[86:87], v[66:67], v[52:53], v[86:87]
    v_pk_fma_f32 v[86:87], v[64:65], v[54:55], v[86:87]
    v_pk_mul_f32 v[88:89], v[72:73], v[48:49]
    v_pk_fma_f32 v[88:89], v[70:71], v[50:51], v[88:89]
    v_pk_fma_f32 v[88:89], v[68:69], v[52:53], v[88:89]
    v_pk_fma_f32 v[88:89], v[66:67], v[54:55], v[88:89]
    v_pk_mul_f32 v[90:91], v[74:75], v[48:49]
    v_pk_fma_f32 v[90:91], v[72:73], v[50:51], v[90:91]
    v_pk_fma_f32 v[90:91], v[70:71], v[52:53], v[90:91]
    v_pk_fma_f32 v[90:91], v[68:69], v[54:55], v[90:91]
    v_pk_mul_f32 v[92:93], v[76:77], v[48:49]
    v_pk_fma_f32 v[92:93], v[74:75], v[50:51], v[92:93]
    v_pk_fma_f32 v[92:93], v[72:73], v[52:53], v[92:93]
    v_pk_fma_f32 v[92:93], v[70:71], v[54:55], v[92:93]
    s_waitcnt lgkmcnt(7)
    v_lshlrev_b32 v94, 16, v27
    v_and_b32 v95, s10, v27
    v_pk_mul_f32 v[78:79], v[78:79], v[94:95]
    s_waitcnt lgkmcnt(6)
    v_lshlrev_b32 v94, 16, v28
    v_and_b32 v95, s10, v28
    v_pk_mul_f32 v[80:81], v[80:81], v[94:95]
    s_waitcnt lgkmcnt(5)
    v_lshlrev_b32 v94, 16, v29
    v_and_b32 v95, s10, v29
    v_pk_mul_f32 v[82:83], v[82:83], v[94:95]
    s_waitcnt lgkmcnt(4)
    v_lshlrev_b32 v94, 16, v30
    v_and_b32 v95, s10, v30
    v_pk_mul_f32 v[84:85], v[84:85], v[94:95]
    s_waitcnt lgkmcnt(3)
    v_lshlrev_b32 v94, 16, v31
    v_and_b32 v95, s10, v31
    v_pk_mul_f32 v[86:87], v[86:87], v[94:95]
    s_waitcnt lgkmcnt(2)
    v_lshlrev_b32 v94, 16, v32
    v_and_b32 v95, s10, v32
    v_pk_mul_f32 v[88:89], v[88:89], v[94:95]
    s_waitcnt lgkmcnt(1)
    v_lshlrev_b32 v94, 16, v33
    v_and_b32 v95, s10, v33
    v_pk_mul_f32 v[90:91], v[90:91], v[94:95]
    s_waitcnt lgkmcnt(0)
    v_lshlrev_b32 v94, 16, v34
    v_and_b32 v95, s10, v34
    v_pk_mul_f32 v[92:93], v[92:93], v[94:95]
    v_cvt_pk_bf16_f32 v96, v92, v90
    v_cvt_pk_bf16_f32 v97, v88, v86
    v_cvt_pk_bf16_f32 v98, v84, v82
    v_cvt_pk_bf16_f32 v99, v80, v78
    buffer_store_dwordx4 v[96:99], v15, s[40:43], 0 offen sc1
    v_cvt_pk_bf16_f32 v100, v93, v91
    v_cvt_pk_bf16_f32 v101, v89, v87
    v_cvt_pk_bf16_f32 v102, v85, v83
    v_cvt_pk_bf16_f32 v103, v81, v79
    buffer_store_dwordx4 v[100:103], v15, s[40:43], s62 offen sc1
    v_mov_b32 v120, v12
    v_mov_b32 v121, v10
    v_mov_b32 v122, v8
    s_add_u32 s56, s4, 0x210000
    s_addc_u32 s57, s5, 0
    s_mov_b32 s58, 0x200000
    s_mov_b32 s59, 0x20000
    s_waitcnt vmcnt(2)
    s_mov_b64 exec, 1
    ds_add_rtn_u32 v6, v3, v5 offset:100
    s_mov_b64 exec, -1
    s_mov_b32 s66, 0
Lsp_9:
    ds_read_b32 v6, v3 offset:100
    s_add_u32 s66, s66, 1
    s_cmp_gt_u32 s66, 8000000
    s_waitcnt lgkmcnt(0)
    s_cbranch_scc1 Lsd_10
    v_readfirstlane_b32 s11, v6
    s_cmp_ge_u32 s11, 4
    s_cbranch_scc0 Lsp_9
Lsd_10:
    ds_read_b32 v35, v120 offset:17408
    ds_read_b32 v36, v120 offset:17536
    ds_read_b32 v37, v120 offset:17664
    ds_read_b32 v38, v120 offset:17792
    ds_read_b32 v39, v120 offset:17920
    ds_read_b32 v40, v120 offset:18048
    ds_read_b32 v41, v120 offset:18176
    ds_read_b32 v42, v120 offset:18304
    s_mov_b32 s64, 0x05040100
    s_mov_b32 s65, 0x07060302
    s_waitcnt lgkmcnt(6)
    v_perm_b32 v104, v36, v35, s64
    v_perm_b32 v108, v36, v35, s65
    s_waitcnt lgkmcnt(4)
    v_perm_b32 v105, v38, v37, s64
    v_perm_b32 v109, v38, v37, s65
    s_waitcnt lgkmcnt(2)
    v_perm_b32 v106, v40, v39, s64
    v_perm_b32 v110, v40, v39, s65
    s_waitcnt lgkmcnt(0)
    v_perm_b32 v107, v42, v41, s64
    v_perm_b32 v111, v42, v41, s65
    v_lshlrev_b32 v119, 12, v121
    v_lshl_add_u32 v119, v122, 4, v119
    s_lshl_b32 s60, s79, 7
    s_add_u32 s61, s60, 4096
    buffer_store_dwordx4 v[104:107], v119, s[56:59], s60 offen sc1
    buffer_store_dwordx4 v[108:111], v119, s[56:59], s61 offen sc1
    s_lshl_b32 s60, s78, 9
    s_lshl_b32 s61, s79, 2
    s_add_u32 s60, s60, s61
    s_add_u32 s60, s60, 0x12dd000
    s_waitcnt vmcnt(2)
    s_mov_b64 exec, 1
    ds_add_rtn_u32 v6, v3, v5 offset:0
    s_mov_b64 exec, -1
    s_waitcnt lgkmcnt(0)
    v_readfirstlane_b32 s11, v6
    s_cmp_lg_u32 s11, 3
    s_cbranch_scc1 Lar_11
    v_mul_u32_u24 v7, 128, v1
    v_add_u32 v7, s60, v7
    v_mov_b32 v6, s100
    s_mov_b64 exec, 0xf
    global_atomic_swap v7, v6, s[4:5] sc1
    s_mov_b64 exec, -1
Lar_11:
    v_lshrrev_b32 v116, 2, v1
    v_lshlrev_b32 v116, 4, v116
    v_and_b32 v117, 3, v1
    v_lshl_add_u32 v116, v117, 2, v116
    s_lshl_b32 s60, s69, 11
    s_add_u32 s60, s60, 4
    v_add_u32 v116, s60, v116
    s_lshl_b32 s73, s70, 12
    s_add_u32 s56, s24, s73
    s_addc_u32 s57, s25, 0
    s_mov_b32 s58, 0x1000
    s_mov_b32 s59, 0x20000
    s_lshl_b32 s61, s69, 13
    s_add_u32 s61, s61, s71
    s_add_u32 s61, s61, 256
    s_add_u32 m0, s61, 0
    s_nop 0
    buffer_load_dwordx4 v116, s[56:59], 0 offen offset:0 lds
    s_add_u32 m0, s61, 768
    s_nop 0
    buffer_load_dwordx4 v116, s[56:59], 0 offen offset:256 lds
    s_add_u32 m0, s61, 1536
    s_nop 0
    buffer_load_dwordx4 v116, s[56:59], 0 offen offset:512 lds
    s_add_u32 m0, s61, 2304
    s_nop 0
    buffer_load_dwordx4 v116, s[56:59], 0 offen offset:768 lds
    s_add_u32 m0, s61, 3072
    s_nop 0
    buffer_load_dwordx4 v116, s[56:59], 0 offen offset:1024 lds
    s_add_u32 m0, s61, 3840
    s_nop 0
    buffer_load_dwordx4 v116, s[56:59], 0 offen offset:1280 lds
    s_add_u32 m0, s61, 4608
    s_nop 0
    buffer_load_dwordx4 v116, s[56:59], 0 offen offset:1536 lds
    s_add_u32 m0, s61, 5376
    s_nop 0
    buffer_load_dwordx4 v116, s[56:59], 0 offen offset:1792 lds
    v_lshrrev_b32 v116, 4, v1
    v_lshlrev_b32 v116, 2, v116
    v_bfe_u32 v118, v1, 2, 2
    v_add3_u32 v116, v116, v118, v117
    v_lshlrev_b32 v116, 2, v116
    v_add_u32 v116, -60, v116
    s_mov_b32 m0, s71
    s_nop 0
    buffer_load_dword v116, s[56:59], 0 offen lds
    s_waitcnt vmcnt(9)
    s_mov_b64 exec, 1
    ds_add_rtn_u32 v6, v3, v5 offset:4
    s_mov_b64 exec, -1
    s_waitcnt lgkmcnt(0)
    v_readfirstlane_b32 s11, v6
    s_cmp_lg_u32 s11, 7
    s_cbranch_scc1 Lar_12
    s_lshl_b32 s60, s6, 7
    s_lshl_b32 s61, s7, 2
    s_add_u32 s60, s60, s61
    s_add_u32 s60, s60, 0x12de000
    v_mul_u32_u24 v7, 1024, v1
    v_add_u32 v7, s60, v7
    v_mov_b32 v6, s100
    s_mov_b64 exec, 0xffff
    global_atomic_swap v7, v6, s[4:5] sc1
    s_mov_b64 exec, -1
Lar_12:
    s_lshl_b32 s60, s69, 1
    v_add_u32 v8, s60, v4
    s_mul_i32 s60, s70, 4224
    s_add_u32 s40, s4, s60
    s_addc_u32 s41, s5, 0
    s_mov_b32 s42, 0x1040
    s_mov_b32 s43, 0x20000
    v_and_b32 v9, 3, v1
    v_lshrrev_b32 v10, 4, v1
    v_and_b32 v11, 15, v1
    v_lshrrev_b32 v12, 2, v11
    v_add_u32 v12, v12, v10
    v_lshlrev_b32 v12, 6, v12
    v_lshl_add_u32 v12, v9, 4, v12
    s_lshl_b32 s60, s69, 10
    s_add_u32 s60, s60, s71
    v_add_u32 v12, s60, v12
    v_lshrrev_b32 v13, 1, v11
    v_lshlrev_b32 v13, 2, v13
    v_sub_u32 v13, v10, v13
    v_lshlrev_b32 v13, 4, v13
    v_and_b32 v14, 1, v1
    v_mul_u32_u24 v14, 4576, v14
    v_sub_u32 v13, v13, v14
    s_lshl_b32 s60, s69, 8
    s_add_u32 s60, s60, s71
    s_add_u32 s60, s60, 21664
    v_add_u32 v13, s60, v13
    s_lshl_b32 s60, s68, 2
    v_add_u32 v15, s60, v3
    v_lshlrev_b32 v9, 7, v10
    v_lshl_add_u32 v9, v11, 2, v9
    v_lshlrev_b32 v14, 2, v9
    s_add_u32 s44, s4, 0x210000
    s_addc_u32 s45, s5, 0
    s_add_u32 s44, s44, s73
    s_addc_u32 s45, s45, 0
    s_mov_b32 s46, 0x1000
    s_mov_b32 s47, 0x20000
    s_add_u32 s48, s4, 0x410000
    s_addc_u32 s49, s5, 0
    s_mov_b32 s50, 0x4000
    s_mov_b32 s51, 0x20000
    s_add_u32 s52, s4, 0x414000
    s_addc_u32 s53, s5, 0
    s_mov_b32 s54, 0x18000
    s_mov_b32 s55, 0x20000
    v_and_b32 v96, 3, v1
    v_mul_u32_u24 v96, 24576, v96
    v_bfe_u32 v97, v1, 2, 2
    v_lshl_add_u32 v97, v97, 12, v96
    s_lshl_b32 s74, s70, 3
    s_and_b32 s60, s70, 0xfffffffe
    s_lshl_b32 s60, s60, 1
    s_load_dword s75, s[26:27], s60
    s_mov_b32 m0, s72
    s_cmp_lg_u32 s3, 0
    s_cbranch_scc1 Lw0_13
    s_lshl_b32 s60, s6, 9
    s_and_b32 s61, s7, 3
    s_lshl_b32 s61, s61, 7
    s_add_u32 s60, s60, s61
    s_add_u32 s60, s60, 0x12dd000
    s_add_u32 s62, s4, s60
    s_addc_u32 s63, s5, 0
    s_mov_b32 s11, 0
Lpo_14:
    s_add_u32 s11, s11, 1
    s_cmp_gt_u32 s11, 1000000
    s_cbranch_scc1 Lpd_16
    s_load_dwordx16 s[16:31], s[62:63], 0 glc
    s_load_dwordx16 s[80:95], s[62:63], 64 glc
Lpc_15:
    s_waitcnt lgkmcnt(0)
    s_cmp_eq_u64 s[16:17], s[100:101]
    s_cbranch_scc0 Lpo_14
    s_cmp_eq_u64 s[18:19], s[100:101]
    s_cbranch_scc0 Lpo_14
    s_cmp_eq_u64 s[20:21], s[100:101]
    s_cbranch_scc0 Lpo_14
    s_cmp_eq_u64 s[22:23], s[100:101]
    s_cbranch_scc0 Lpo_14
    s_cmp_eq_u64 s[24:25], s[100:101]
    s_cbranch_scc0 Lpo_14
    s_cmp_eq_u64 s[26:27], s[100:101]
    s_cbranch_scc0 Lpo_14
    s_cmp_eq_u64 s[28:29], s[100:101]
    s_cbranch_scc0 Lpo_14
    s_cmp_eq_u64 s[30:31], s[100:101]
    s_cbranch_scc0 Lpo_14
    s_cmp_eq_u64 s[80:81], s[100:101]
    s_cbranch_scc0 Lpo_14
    s_cmp_eq_u64 s[82:83], s[100:101]
    s_cbranch_scc0 Lpo_14
    s_cmp_eq_u64 s[84:85], s[100:101]
    s_cbranch_scc0 Lpo_14
    s_cmp_eq_u64 s[86:87], s[100:101]
    s_cbranch_scc0 Lpo_14
    s_cmp_eq_u64 s[88:89], s[100:101]
    s_cbranch_scc0 Lpo_14
    s_cmp_eq_u64 s[90:91], s[100:101]
    s_cbranch_scc0 Lpo_14
    s_cmp_eq_u64 s[92:93], s[100:101]
    s_cbranch_scc0 Lpo_14
    s_cmp_eq_u64 s[94:95], s[100:101]
    s_cbranch_scc0 Lpo_14
Lpd_16:
    v_mov_b32 v6, 1
    ds_write_b32 v3, v6 offset:12
Lw0_13:
    s_mov_b32 s66, 0
Lsp_17:
    ds_read_b32 v6, v3 offset:12
    s_add_u32 s66, s66, 1
    s_cmp_gt_u32 s66, 8000000
    s_waitcnt lgkmcnt(0)
    s_cbranch_scc1 Lsd_18
    v_readfirstlane_b32 s11, v6
    s_cmp_ge_u32 s11, 1
    s_cbranch_scc0 Lsp_17
Lsd_18:
    buffer_load_dwordx4 v8, s[40:43], 0 offen offset:0 sc1 lds
    buffer_load_dwordx4 v8, s[40:43], 0 offen offset:1024 sc1 lds
    buffer_load_dwordx4 v8, s[40:43], 0 offen offset:2048 sc1 lds
    buffer_load_dwordx4 v8, s[40:43], 0 offen offset:3072 sc1 lds
    s_waitcnt vmcnt(0)
    s_mov_b64 exec, 1
    ds_add_rtn_u32 v6, v15, v5 offset:20
    s_mov_b64 exec, -1
    s_mov_b32 s66, 0
Lsp_20:
    ds_read_b32 v6, v15 offset:20
    s_add_u32 s66, s66, 1
    s_cmp_gt_u32 s66, 8000000
    s_waitcnt lgkmcnt(0)
    s_cbranch_scc1 Lsd_21
    v_readfirstlane_b32 s11, v6
    s_cmp_ge_u32 s11, 2
    s_cbranch_scc0 Lsp_20
Lsd_21:
    ds_read_b128 v[128:131], v13 offset:3584
    ds_read_b128 v[160:163], v12 offset:0
    ds_read_b128 v[132:135], v13 offset:3072
    ds_read_b128 v[164:167], v12 offset:2048
    ds_read_b128 v[136:139], v13 offset:2560
    ds_read_b128 v[168:171], v12 offset:4096
    ds_read_b128 v[140:143], v13 offset:2048
    ds_read_b128 v[172:175], v12 offset:6144
    ds_read_b128 v[144:147], v13 offset:1536
    ds_read_b128 v[176:179], v12 offset:8192
    ds_read_b128 v[148:151], v13 offset:1024
    ds_read_b128 v[180:183], v12 offset:10240
    ds_read_b128 v[152:155], v13 offset:512
    ds_read_b128 v[184:187], v12 offset:12288
    ds_read_b128 v[156:159], v13 offset:0
    ds_read_b128 v[188:191], v12 offset:14336
    s_lshl_b32 s76, s69, 11
    s_lshl_b32 s77, s69, 13
    s_add_u32 s78, s77, 4096
    s_waitcnt lgkmcnt(14)
    v_mfma_f32_16x16x32_bf16 v[16:19], v[128:131], v[160:163], 0
    s_waitcnt lgkmcnt(13)
    v_mfma_f32_16x16x32_bf16 v[20:23], v[132:135], v[160:163], 0
    s_waitcnt lgkmcnt(12)
    v_mfma_f32_16x16x32_bf16 v[20:23], v[128:131], v[164:167], v[20:23]
    ds_read_b128 v[192:195], v13 offset:3648
    v_mfma_f32_16x16x32_bf16 v[24:27], v[132:135], v[164:167], 0
    s_waitcnt lgkmcnt(12)
    v_mfma_f32_16x16x32_bf16 v[24:27], v[136:139], v[160:163], v[24:27]
    ds_read_b128 v[224:227], v12 offset:256
    v_mfma_f32_16x16x32_bf16 v[28:31], v[136:139], v[164:167], 0
    s_waitcnt lgkmcnt(12)
    v_mfma_f32_16x16x32_bf16 v[24:27], v[128:131], v[168:171], v[24:27]
    ds_read_b128 v[196:199], v13 offset:3136
    v_mfma_f32_16x16x32_bf16 v[28:31], v[132:135], v[168:171], v[28:31]
    v_mfma_f32_16x16x32_bf16 v[32:35], v[136:139], v[168:171], 0
    ds_read_b128 v[228:231], v12 offset:2304
    s_waitcnt lgkmcnt(13)
    v_mfma_f32_16x16x32_bf16 v[28:31], v[140:143], v[160:163], v[28:31]
    v_mfma_f32_16x16x32_bf16 v[32:35], v[140:143], v[164:167], v[32:35]
    ds_read_b128 v[200:203], v13 offset:2624
    v_mfma_f32_16x16x32_bf16 v[36:39], v[140:143], v[168:171], 0
    s_waitcnt lgkmcnt(13)
    v_mfma_f32_16x16x32_bf16 v[28:31], v[128:131], v[172:175], v[28:31]
    ds_read_b128 v[232:235], v12 offset:4352
    v_mfma_f32_16x16x32_bf16 v[32:35], v[132:135], v[172:175], v[32:35]
    v_mfma_f32_16x16x32_bf16 v[36:39], v[136:139], v[172:175], v[36:39]
    ds_read_b128 v[204:207], v13 offset:2112
    v_mfma_f32_16x16x32_bf16 v[40:43], v[140:143], v[172:175], 0
    s_waitcnt lgkmcnt(14)
    v_mfma_f32_16x16x32_bf16 v[32:35], v[144:147], v[160:163], v[32:35]
    ds_read_b128 v[236:239], v12 offset:6400
    v_mfma_f32_16x16x32_bf16 v[36:39], v[144:147], v[164:167], v[36:39]
    v_mfma_f32_16x16x32_bf16 v[40:43], v[144:147], v[168:171], v[40:43]
    ds_read_b128 v[208:211], v13 offset:1600
    v_mfma_f32_16x16x32_bf16 v[44:47], v[144:147], v[172:175], 0
    s_waitcnt lgkmcnt(15)
    v_mfma_f32_16x16x32_bf16 v[32:35], v[128:131], v[176:179], v[32:35]
    ds_read_b128 v[240:243], v12 offset:8448
    v_mfma_f32_16x16x32_bf16 v[36:39], v[132:135], v[176:179], v[36:39]
    v_mfma_f32_16x16x32_bf16 v[40:43], v[136:139], v[176:179], v[40:43]
    ds_read_b128 v[212:215], v13 offset:1088
    v_mfma_f32_16x16x32_bf16 v[44:47], v[140:143], v[176:179], v[44:47]
    s_waitcnt lgkmcnt(15)
    v_mfma_f32_16x16x32_bf16 v[36:39], v[148:151], v[160:163], v[36:39]
    ds_read_b128 v[244:247], v12 offset:10496
    v_mfma_f32_16x16x32_bf16 v[40:43], v[148:151], v[164:167], v[40:43]
    v_mfma_f32_16x16x32_bf16 v[44:47], v[148:151], v[168:171], v[44:47]
    ds_read_b128 v[216:219], v13 offset:576
    v_mfma_f32_16x16x32_bf16 v[36:39], v[128:131], v[180:183], v[36:39]
    v_mfma_f32_16x16x32_bf16 v[40:43], v[132:135], v[180:183], v[40:43]
    ds_read_b128 v[248:251], v12 offset:12544
    v_mfma_f32_16x16x32_bf16 v[44:47], v[136:139], v[180:183], v[44:47]
    s_waitcnt lgkmcnt(15)
    v_mfma_f32_16x16x32_bf16 v[40:43], v[152:155], v[160:163], v[40:43]
    ds_read_b128 v[220:223], v13 offset:64
    v_mfma_f32_16x16x32_bf16 v[44:47], v[152:155], v[164:167], v[44:47]
    v_mfma_f32_16x16x32_bf16 v[40:43], v[128:131], v[184:187], v[40:43]
    ds_read_b128 v[252:255], v12 offset:14592
    v_mfma_f32_16x16x32_bf16 v[44:47], v[132:135], v[184:187], v[44:47]
    v_mfma_f32_16x16x32_bf16 v[44:47], v[156:159], v[160:163], v[44:47]
    s_waitcnt lgkmcnt(15)
    v_mfma_f32_16x16x32_bf16 v[44:47], v[128:131], v[188:191], v[44:47]
    s_cmp_lg_u32 s3, 0
    s_cbranch_scc1 Lq_22
    s_and_b32 s61, s7, 15
    s_lshl_b32 s61, s61, 10
    s_add_u32 s61, s61, 0x12de000
    v_add_u32 v8, s61, v4
    global_load_dwordx4 v[104:107], v8, s[4:5] sc1
Lq_22:
    s_waitcnt lgkmcnt(14)
    v_mfma_f32_16x16x32_bf16 v[16:19], v[192:195], v[224:227], v[16:19]
    s_waitcnt lgkmcnt(13)
    v_mfma_f32_16x16x32_bf16 v[20:23], v[196:199], v[224:227], v[20:23]
    s_waitcnt lgkmcnt(12)
    v_mfma_f32_16x16x32_bf16 v[20:23], v[192:195], v[228:231], v[20:23]
    ds_read_b128 v[128:131], v13 offset:3712
    v_mfma_f32_16x16x32_bf16 v[24:27], v[196:199], v[228:231], v[24:27]
    s_waitcnt lgkmcnt(12)
    v_mfma_f32_16x16x32_bf16 v[24:27], v[200:203], v[224:227], v[24:27]
    ds_read_b128 v[160:163], v12 offset:512
    v_mfma_f32_16x16x32_bf16 v[28:31], v[200:203], v[228:231], v[28:31]
    s_waitcnt lgkmcnt(12)
    v_mfma_f32_16x16x32_bf16 v[24:27], v[192:195], v[232:235], v[24:27]
    ds_read_b128 v[132:135], v13 offset:3200
    v_mfma_f32_16x16x32_bf16 v[28:31], v[196:199], v[232:235], v[28:31]
    v_mfma_f32_16x16x32_bf16 v[32:35], v[200:203], v[232:235], v[32:35]
    ds_read_b128 v[164:167], v12 offset:2560
    s_waitcnt lgkmcnt(13)
    v_mfma_f32_16x16x32_bf16 v[28:31], v[204:207], v[224:227], v[28:31]
    v_mfma_f32_16x16x32_bf16 v[32:35], v[204:207], v[228:231], v[32:35]
    ds_read_b128 v[136:139], v13 offset:2688
    v_mfma_f32_16x16x32_bf16 v[36:39], v[204:207], v[232:235], v[36:39]
    s_waitcnt lgkmcnt(13)
    v_mfma_f32_16x16x32_bf16 v[28:31], v[192:195], v[236:239], v[28:31]
    ds_read_b128 v[168:171], v12 offset:4608
    v_mfma_f32_16x16x32_bf16 v[32:35], v[196:199], v[236:239], v[32:35]
    v_mfma_f32_16x16x32_bf16 v[36:39], v[200:203], v[236:239], v[36:39]
    ds_read_b128 v[140:143], v13 offset:2176
    v_mfma_f32_16x16x32_bf16 v[40:43], v[204:207], v[236:239], v[40:43]
    s_waitcnt lgkmcnt(14)
    v_mfma_f32_16x16x32_bf16 v[32:35], v[208:211], v[224:227], v[32:35]
    ds_read_b128 v[172:175], v12 offset:6656
    v_mfma_f32_16x16x32_bf16 v[36:39], v[208:211], v[228:231], v[36:39]
    v_mfma_f32_16x16x32_bf16 v[40:43], v[208:211], v[232:235], v[40:43]
    ds_read_b128 v[144:147], v13 offset:1664
    v_mfma_f32_16x16x32_bf16 v[44:47], v[208:211], v[236:239], v[44:47]
    s_waitcnt lgkmcnt(15)
    v_mfma_f32_16x16x32_bf16 v[32:35], v[192:195], v[240:243], v[32:35]
    ds_read_b128 v[176:179], v12 offset:8704
    v_mfma_f32_16x16x32_bf16 v[36:39], v[196:199], v[240:243], v[36:39]
    v_mfma_f32_16x16x32_bf16 v[40:43], v[200:203], v[240:243], v[40:43]
    ds_read_b128 v[148:151], v13 offset:1152
    v_mfma_f32_16x16x32_bf16 v[44:47], v[204:207], v[240:243], v[44:47]
    s_waitcnt lgkmcnt(15)
    v_mfma_f32_16x16x32_bf16 v[36:39], v[212:215], v[224:227], v[36:39]
    ds_read_b128 v[180:183], v12 offset:10752
    v_mfma_f32_16x16x32_bf16 v[40:43], v[212:215], v[228:231], v[40:43]
    v_mfma_f32_16x16x32_bf16 v[44:47], v[212:215], v[232:235], v[44:47]
    ds_read_b128 v[152:155], v13 offset:640
    v_mfma_f32_16x16x32_bf16 v[36:39], v[192:195], v[244:247], v[36:39]
    v_mfma_f32_16x16x32_bf16 v[40:43], v[196:199], v[244:247], v[40:43]
    ds_read_b128 v[184:187], v12 offset:12800
    v_mfma_f32_16x16x32_bf16 v[44:47], v[200:203], v[244:247], v[44:47]
    s_waitcnt lgkmcnt(15)
    v_mfma_f32_16x16x32_bf16 v[40:43], v[216:219], v[224:227], v[40:43]
    ds_read_b128 v[156:159], v13 offset:128
    v_mfma_f32_16x16x32_bf16 v[44:47], v[216:219], v[228:231], v[44:47]
    v_mfma_f32_16x16x32_bf16 v[40:43], v[192:195], v[248:251], v[40:43]
    ds_read_b128 v[188:191], v12 offset:14848
    v_mfma_f32_16x16x32_bf16 v[44:47], v[196:199], v[248:251], v[44:47]
    v_mfma_f32_16x16x32_bf16 v[44:47], v[220:223], v[224:227], v[44:47]
    s_waitcnt lgkmcnt(15)
    v_mfma_f32_16x16x32_bf16 v[44:47], v[192:195], v[252:255], v[44:47]
    s_cmp_lg_u32 s3, 0
    s_cbranch_scc1 Lq_23
    s_mov_b32 s11, 0
    s_branch Lq_25
Lq_24:
    global_load_dwordx4 v[104:107], v8, s[4:5] sc1
    s_add_u32 s11, s11, 1
Lq_25:
    s_waitcnt vmcnt(0)
    v_xor_b32 v104, s100, v104
    v_xor_b32 v105, s100, v105
    v_xor_b32 v106, s100, v106
    v_xor_b32 v107, s100, v107
    v_or3_b32 v104, v104, v105, v106
    v_or_b32 v104, v104, v107
    v_cmp_ne_u32 vcc, 0, v104
    s_cmp_gt_u32 s11, 1000000
    s_cselect_b64 vcc, 0, vcc
    s_cmp_lg_u64 vcc, 0
    s_cbranch_scc1 Lq_24
    v_mov_b32 v6, 1
    ds_write_b32 v3, v6 offset:16
Lq_23:
    s_mov_b32 s66, 0
Lsp_26:
    ds_read_b32 v6, v3 offset:16
    s_add_u32 s66, s66, 1
    s_cmp_gt_u32 s66, 8000000
    s_waitcnt lgkmcnt(0)
    s_cbranch_scc1 Lsd_27
    v_readfirstlane_b32 s11, v6
    s_cmp_ge_u32 s11, 1
    s_cbranch_scc0 Lsp_26
Lsd_27:
    v_mfma_f32_16x16x32_bf16 v[16:19], v[128:131], v[160:163], v[16:19]
    v_mfma_f32_16x16x32_bf16 v[20:23], v[132:135], v[160:163], v[20:23]
    buffer_load_dword v96, v97, s[52:55], s74 offen sc1
    v_mfma_f32_16x16x32_bf16 v[20:23], v[128:131], v[164:167], v[20:23]
    ds_read_b128 v[192:195], v13 offset:3776
    v_mfma_f32_16x16x32_bf16 v[24:27], v[132:135], v[164:167], v[24:27]
    v_mfma_f32_16x16x32_bf16 v[24:27], v[136:139], v[160:163], v[24:27]
    ds_read_b128 v[224:227], v12 offset:768
    buffer_load_dword v48, v9, s[44:47], s76 offen offset:0 sc1
    v_mfma_f32_16x16x32_bf16 v[28:31], v[136:139], v[164:167], v[28:31]
    v_mfma_f32_16x16x32_bf16 v[24:27], v[128:131], v[168:171], v[24:27]
    ds_read_b128 v[196:199], v13 offset:3264
    v_mfma_f32_16x16x32_bf16 v[28:31], v[132:135], v[168:171], v[28:31]
    buffer_load_dwordx4 v[56:59], v14, s[48:51], s77 offen offset:0 sc1
    v_mfma_f32_16x16x32_bf16 v[32:35], v[136:139], v[168:171], v[32:35]
    ds_read_b128 v[228:231], v12 offset:2816
    v_mfma_f32_16x16x32_bf16 v[28:31], v[140:143], v[160:163], v[28:31]
    v_mfma_f32_16x16x32_bf16 v[32:35], v[140:143], v[164:167], v[32:35]
    ds_read_b128 v[200:203], v13 offset:2752
    buffer_load_dword v49, v9, s[44:47], s76 offen offset:64 sc1
    v_mfma_f32_16x16x32_bf16 v[36:39], v[140:143], v[168:171], v[36:39]
    v_mfma_f32_16x16x32_bf16 v[28:31], v[128:131], v[172:175], v[28:31]
    ds_read_b128 v[232:235], v12 offset:4864
    v_mfma_f32_16x16x32_bf16 v[32:35], v[132:135], v[172:175], v[32:35]
    buffer_load_dwordx4 v[60:63], v14, s[48:51], s77 offen offset:256 sc1
    v_mfma_f32_16x16x32_bf16 v[36:39], v[136:139], v[172:175], v[36:39]
    ds_read_b128 v[204:207], v13 offset:2240
    v_mfma_f32_16x16x32_bf16 v[40:43], v[140:143], v[172:175], v[40:43]
    v_mfma_f32_16x16x32_bf16 v[32:35], v[144:147], v[160:163], v[32:35]
    ds_read_b128 v[236:239], v12 offset:6912
    buffer_load_dword v50, v9, s[44:47], s76 offen offset:512 sc1
    v_mfma_f32_16x16x32_bf16 v[36:39], v[144:147], v[164:167], v[36:39]
    v_mfma_f32_16x16x32_bf16 v[40:43], v[144:147], v[168:171], v[40:43]
    ds_read_b128 v[208:211], v13 offset:1728
    v_mfma_f32_16x16x32_bf16 v[44:47], v[144:147], v[172:175], v[44:47]
    buffer_load_dwordx4 v[64:67], v14, s[48:51], s77 offen offset:2048 sc1
    v_mfma_f32_16x16x32_bf16 v[32:35], v[128:131], v[176:179], v[32:35]
    ds_read_b128 v[240:243], v12 offset:8960
    v_mfma_f32_16x16x32_bf16 v[36:39], v[132:135], v[176:179], v[36:39]
    v_mfma_f32_16x16x32_bf16 v[40:43], v[136:139], v[176:179], v[40:43]
    ds_read_b128 v[212:215], v13 offset:1216
    buffer_load_dword v51, v9, s[44:47], s76 offen offset:576 sc1
    v_mfma_f32_16x16x32_bf16 v[44:47], v[140:143], v[176:179], v[44:47]
    v_mfma_f32_16x16x32_bf16 v[36:39], v[148:151], v[160:163], v[36:39]
    ds_read_b128 v[244:247], v12 offset:11008
    v_mfma_f32_16x16x32_bf16 v[40:43], v[148:151], v[164:167], v[40:43]
    buffer_load_dwordx4 v[68:71], v14, s[48:51], s77 offen offset:2304 sc1
    v_mfma_f32_16x16x32_bf16 v[44:47], v[148:151], v[168:171], v[44:47]
    ds_read_b128 v[216:219], v13 offset:704
    v_mfma_f32_16x16x32_bf16 v[36:39], v[128:131], v[180:183], v[36:39]
    v_mfma_f32_16x16x32_bf16 v[40:43], v[132:135], v[180:183], v[40:43]
    ds_read_b128 v[248:251], v12 offset:13056
    buffer_load_dword v52, v9, s[44:47], s76 offen offset:1024 sc1
    v_mfma_f32_16x16x32_bf16 v[44:47], v[136:139], v[180:183], v[44:47]
    v_mfma_f32_16x16x32_bf16 v[40:43], v[152:155], v[160:163], v[40:43]
    ds_read_b128 v[220:223], v13 offset:192
    v_mfma_f32_16x16x32_bf16 v[44:47], v[152:155], v[164:167], v[44:47]
    buffer_load_dwordx4 v[72:75], v14, s[48:51], s78 offen offset:0 sc1
    v_mfma_f32_16x16x32_bf16 v[40:43], v[128:131], v[184:187], v[40:43]
    ds_read_b128 v[252:255], v12 offset:15104
    v_mfma_f32_16x16x32_bf16 v[44:47], v[132:135], v[184:187], v[44:47]
    v_mfma_f32_16x16x32_bf16 v[44:47], v[156:159], v[160:163], v[44:47]
    buffer_load_dword v53, v9, s[44:47], s76 offen offset:1088 sc1
    v_mfma_f32_16x16x32_bf16 v[44:47], v[128:131], v[188:191], v[44:47]
    s_waitcnt lgkmcnt(14)
    v_mfma_f32_16x16x32_bf16 v[16:19], v[192:195], v[224:227], v[16:19]
    s_waitcnt lgkmcnt(13)
    v_mfma_f32_16x16x32_bf16 v[20:23], v[196:199], v[224:227], v[20:23]
    buffer_load_dwordx4 v[76:79], v14, s[48:51], s78 offen offset:256 sc1
    s_waitcnt lgkmcnt(12)
    v_mfma_f32_16x16x32_bf16 v[20:23], v[192:195], v[228:231], v[20:23]
    v_mfma_f32_16x16x32_bf16 v[24:27], v[196:199], v[228:231], v[24:27]
    s_waitcnt lgkmcnt(11)
    v_mfma_f32_16x16x32_bf16 v[24:27], v[200:203], v[224:227], v[24:27]
    buffer_load_dword v54, v9, s[44:47], s76 offen offset:1536 sc1
    v_mfma_f32_16x16x32_bf16 v[28:31], v[200:203], v[228:231], v[28:31]
    s_waitcnt lgkmcnt(10)
    v_mfma_f32_16x16x32_bf16 v[24:27], v[192:195], v[232:235], v[24:27]
    v_mfma_f32_16x16x32_bf16 v[28:31], v[196:199], v[232:235], v[28:31]
    buffer_load_dwordx4 v[80:83], v14, s[48:51], s78 offen offset:2048 sc1
    v_mfma_f32_16x16x32_bf16 v[32:35], v[200:203], v[232:235], v[32:35]
    s_waitcnt lgkmcnt(9)
    v_mfma_f32_16x16x32_bf16 v[28:31], v[204:207], v[224:227], v[28:31]
    v_mfma_f32_16x16x32_bf16 v[32:35], v[204:207], v[228:231], v[32:35]
    buffer_load_dword v55, v9, s[44:47], s76 offen offset:1600 sc1
    v_mfma_f32_16x16x32_bf16 v[36:39], v[204:207], v[232:235], v[36:39]
    s_waitcnt lgkmcnt(8)
    v_mfma_f32_16x16x32_bf16 v[28:31], v[192:195], v[236:239], v[28:31]
    v_mfma_f32_16x16x32_bf16 v[32:35], v[196:199], v[236:239], v[32:35]
    buffer_load_dwordx4 v[84:87], v14, s[48:51], s78 offen offset:2304 sc1
    v_mfma_f32_16x16x32_bf16 v[36:39], v[200:203], v[236:239], v[36:39]
    v_mfma_f32_16x16x32_bf16 v[40:43], v[204:207], v[236:239], v[40:43]
    s_waitcnt lgkmcnt(7)
    v_mfma_f32_16x16x32_bf16 v[32:35], v[208:211], v[224:227], v[32:35]
    v_mfma_f32_16x16x32_bf16 v[36:39], v[208:211], v[228:231], v[36:39]
    v_mfma_f32_16x16x32_bf16 v[40:43], v[208:211], v[232:235], v[40:43]
    v_mfma_f32_16x16x32_bf16 v[44:47], v[208:211], v[236:239], v[44:47]
    s_waitcnt lgkmcnt(6)
    v_mfma_f32_16x16x32_bf16 v[32:35], v[192:195], v[240:243], v[32:35]
    s_lshl_b32 s60, s3, 12
    s_add_u32 s60, s60, 51712
    v_add_u32 v103, s60, v4
    s_xor_b32 s60, s3, 1
    s_lshl_b32 s60, s60, 12
    s_add_u32 s60, s60, 51712
    v_add_u32 v104, s60, v4
    s_sub_u32 s60, s71, s76
    s_add_u32 s60, s60, 19132
    v_sub_u32 v8, s60, v9
    ds_read_b32 v88, v8 offset:1600
    ds_read_b32 v89, v8 offset:1536
    ds_read_b32 v90, v8 offset:1088
    ds_read_b32 v91, v8 offset:1024
    ds_read_b32 v92, v8 offset:576
    ds_read_b32 v93, v8 offset:512
    ds_read_b32 v94, v8 offset:64
    ds_read_b32 v95, v8 offset:0
    v_mfma_f32_16x16x32_bf16 v[36:39], v[196:199], v[240:243], v[36:39]
    v_mfma_f32_16x16x32_bf16 v[40:43], v[200:203], v[240:243], v[40:43]
    v_mfma_f32_16x16x32_bf16 v[44:47], v[204:207], v[240:243], v[44:47]
    s_waitcnt lgkmcnt(13)
    v_mfma_f32_16x16x32_bf16 v[36:39], v[212:215], v[224:227], v[36:39]
    v_mfma_f32_16x16x32_bf16 v[40:43], v[212:215], v[228:231], v[40:43]
    v_mfma_f32_16x16x32_bf16 v[44:47], v[212:215], v[232:235], v[44:47]
    s_waitcnt lgkmcnt(12)
    v_mfma_f32_16x16x32_bf16 v[36:39], v[192:195], v[244:247], v[36:39]
    v_mfma_f32_16x16x32_bf16 v[40:43], v[196:199], v[244:247], v[40:43]
    v_mfma_f32_16x16x32_bf16 v[44:47], v[200:203], v[244:247], v[44:47]
    s_waitcnt lgkmcnt(11)
    v_mfma_f32_16x16x32_bf16 v[40:43], v[216:219], v[224:227], v[40:43]
    v_mfma_f32_16x16x32_bf16 v[44:47], v[216:219], v[228:231], v[44:47]
    s_waitcnt lgkmcnt(10)
    v_mfma_f32_16x16x32_bf16 v[40:43], v[192:195], v[248:251], v[40:43]
    v_mfma_f32_16x16x32_bf16 v[44:47], v[196:199], v[248:251], v[44:47]
    s_waitcnt lgkmcnt(9)
    v_mfma_f32_16x16x32_bf16 v[44:47], v[220:223], v[224:227], v[44:47]
    s_waitcnt lgkmcnt(8)
    v_mfma_f32_16x16x32_bf16 v[44:47], v[192:195], v[252:255], v[44:47]
    s_nop 5
    s_cmp_eq_u32 s69, 0
    s_cbranch_scc0 Lx_28
    ds_write_b128 v103, v[32:35] offset:0
    ds_write_b128 v103, v[36:39] offset:1024
    ds_write_b128 v103, v[40:43] offset:2048
    ds_write_b128 v103, v[44:47] offset:3072
    s_branch Lx_29
Lx_28:
    ds_write_b128 v103, v[16:19] offset:0
    ds_write_b128 v103, v[20:23] offset:1024
    ds_write_b128 v103, v[24:27] offset:2048
    ds_write_b128 v103, v[28:31] offset:3072
    v_mov_b32 v16, v32
    v_mov_b32 v17, v33
    v_mov_b32 v18, v34
    v_mov_b32 v19, v35
    v_mov_b32 v20, v36
    v_mov_b32 v21, v37
    v_mov_b32 v22, v38
    v_mov_b32 v23, v39
    v_mov_b32 v24, v40
    v_mov_b32 v25, v41
    v_mov_b32 v26, v42
    v_mov_b32 v27, v43
    v_mov_b32 v28, v44
    v_mov_b32 v29, v45
    v_mov_b32 v30, v46
    v_mov_b32 v31, v47
Lx_29:
    s_mov_b64 exec, 1
    ds_add_rtn_u32 v6, v15, v5 offset:28
    s_mov_b64 exec, -1
    s_waitcnt vmcnt(16)
    v_add_f32_dpp v96, v96, v96 quad_perm:[1,0,3,2] row_mask:0xf bank_mask:0xf
    s_nop 1
    v_add_f32_dpp v96, v96, v96 quad_perm:[2,3,0,1] row_mask:0xf bank_mask:0xf
    v_cvt_pk_bf16_f32 v96, v96, v96
    v_and_b32 v96, s10, v96
    v_add_f32 v97, 1.0, v96
    v_cvt_pk_bf16_f32 v97, v97, v97
    v_and_b32 v97, s10, v97
    v_readlane_b32 s60, v96, 0
    v_readlane_b32 s61, v97, 4
    v_readlane_b32 s62, v96, 8
    s_lshl_b32 s63, s75, 16
    s_and_b32 s75, s75, s10
    s_cmp_eq_u32 s68, 0
    s_cselect_b32 s75, s63, s75
    v_mov_b32 v98, s61
    v_mov_b32 v99, s60
    v_mov_b32 v100, s75
    v_mov_b32 v101, s62
    s_lshl_b32 s60, s70, 6
    s_add_u32 s40, s4, 0x42c000
    s_addc_u32 s41, s5, 0
    s_add_u32 s40, s40, s60
    s_addc_u32 s41, s41, 0
    s_mov_b32 s42, 0x1f8040
    s_mov_b32 s43, 0x20000
    v_lshlrev_b32 v9, 16, v10
    v_lshl_add_u32 v9, v11, 2, v9
    s_lshl_b32 s76, s69, 20
    s_waitcnt vmcnt(15)
    v_lshlrev_b32 v128, 16, v48
    v_and_b32 v129, s10, v48
    s_waitcnt vmcnt(14)
    v_fma_f32 v130, v128, v56, v57
    v_fma_f32 v131, v129, v58, v59
    v_pk_fma_f32 v[130:131], v[130:131], v[98:99], v[98:99] op_sel:[0,0,1] op_sel_hi:[1,0,1]
    s_waitcnt lgkmcnt(8)
    v_and_b32 v56, s10, v88
    v_lshlrev_b32 v57, 16, v88
    v_pk_fma_f32 v[16:17], v[56:57], v[100:101], v[16:17] op_sel:[0,0,0] op_sel_hi:[1,0,1]
    s_waitcnt vmcnt(13)
    v_lshlrev_b32 v132, 16, v49
    v_and_b32 v133, s10, v49
    s_waitcnt vmcnt(12)
    v_fma_f32 v134, v132, v60, v61
    v_fma_f32 v135, v133, v62, v63
    v_pk_fma_f32 v[134:135], v[134:135], v[98:99], v[98:99] op_sel:[0,0,1] op_sel_hi:[1,0,1]
    s_waitcnt lgkmcnt(7)
    v_and_b32 v60, s10, v89
    v_lshlrev_b32 v61, 16, v89
    v_pk_fma_f32 v[18:19], v[60:61], v[100:101], v[18:19] op_sel:[0,0,0] op_sel_hi:[1,0,1]
    s_waitcnt vmcnt(11)
    v_lshlrev_b32 v136, 16, v50
    v_and_b32 v137, s10, v50
    s_waitcnt vmcnt(10)
    v_fma_f32 v138, v136, v64, v65
    v_fma_f32 v139, v137, v66, v67
    v_pk_fma_f32 v[138:139], v[138:139], v[98:99], v[98:99] op_sel:[0,0,1] op_sel_hi:[1,0,1]
    s_waitcnt lgkmcnt(6)
    v_and_b32 v64, s10, v90
    v_lshlrev_b32 v65, 16, v90
    v_pk_fma_f32 v[20:21], v[64:65], v[100:101], v[20:21] op_sel:[0,0,0] op_sel_hi:[1,0,1]
    s_waitcnt vmcnt(9)
    v_lshlrev_b32 v140, 16, v51
    v_and_b32 v141, s10, v51
    s_waitcnt vmcnt(8)
    v_fma_f32 v142, v140, v68, v69
    v_fma_f32 v143, v141, v70, v71
    v_pk_fma_f32 v[142:143], v[142:143], v[98:99], v[98:99] op_sel:[0,0,1] op_sel_hi:[1,0,1]
    s_waitcnt lgkmcnt(5)
    v_and_b32 v68, s10, v91
    v_lshlrev_b32 v69, 16, v91
    v_pk_fma_f32 v[22:23], v[68:69], v[100:101], v[22:23] op_sel:[0,0,0] op_sel_hi:[1,0,1]
    s_waitcnt vmcnt(7)
    v_lshlrev_b32 v144, 16, v52
    v_and_b32 v145, s10, v52
    s_waitcnt vmcnt(6)
    v_fma_f32 v146, v144, v72, v73
    v_fma_f32 v147, v145, v74, v75
    v_pk_fma_f32 v[146:147], v[146:147], v[98:99], v[98:99] op_sel:[0,0,1] op_sel_hi:[1,0,1]
    s_waitcnt lgkmcnt(4)
    v_and_b32 v72, s10, v92
    v_lshlrev_b32 v73, 16, v92
    v_pk_fma_f32 v[24:25], v[72:73], v[100:101], v[24:25] op_sel:[0,0,0] op_sel_hi:[1,0,1]
    s_waitcnt vmcnt(5)
    v_lshlrev_b32 v148, 16, v53
    v_and_b32 v149, s10, v53
    s_waitcnt vmcnt(4)
    v_fma_f32 v150, v148, v76, v77
    v_fma_f32 v151, v149, v78, v79
    v_pk_fma_f32 v[150:151], v[150:151], v[98:99], v[98:99] op_sel:[0,0,1] op_sel_hi:[1,0,1]
    s_waitcnt lgkmcnt(3)
    v_and_b32 v76, s10, v93
    v_lshlrev_b32 v77, 16, v93
    v_pk_fma_f32 v[26:27], v[76:77], v[100:101], v[26:27] op_sel:[0,0,0] op_sel_hi:[1,0,1]
    s_waitcnt vmcnt(3)
    v_lshlrev_b32 v152, 16, v54
    v_and_b32 v153, s10, v54
    s_waitcnt vmcnt(2)
    v_fma_f32 v154, v152, v80, v81
    v_fma_f32 v155, v153, v82, v83
    v_pk_fma_f32 v[154:155], v[154:155], v[98:99], v[98:99] op_sel:[0,0,1] op_sel_hi:[1,0,1]
    s_waitcnt lgkmcnt(2)
    v_and_b32 v80, s10, v94
    v_lshlrev_b32 v81, 16, v94
    v_pk_fma_f32 v[28:29], v[80:81], v[100:101], v[28:29] op_sel:[0,0,0] op_sel_hi:[1,0,1]
    s_waitcnt vmcnt(1)
    v_lshlrev_b32 v156, 16, v55
    v_and_b32 v157, s10, v55
    s_waitcnt vmcnt(0)
    v_fma_f32 v158, v156, v84, v85
    v_fma_f32 v159, v157, v86, v87
    v_pk_fma_f32 v[158:159], v[158:159], v[98:99], v[98:99] op_sel:[0,0,1] op_sel_hi:[1,0,1]
    s_waitcnt lgkmcnt(1)
    v_and_b32 v84, s10, v95
    v_lshlrev_b32 v85, 16, v95
    v_pk_fma_f32 v[30:31], v[84:85], v[100:101], v[30:31] op_sel:[0,0,0] op_sel_hi:[1,0,1]
    s_mov_b32 s66, 0
Lsp_31:
    ds_read_b32 v6, v15 offset:28
    s_add_u32 s66, s66, 1
    s_cmp_gt_u32 s66, 8000000
    s_waitcnt lgkmcnt(0)
    s_cbranch_scc1 Lsd_32
    v_readfirstlane_b32 s11, v6
    s_cmp_ge_u32 s11, 2
    s_cbranch_scc0 Lsp_31
Lsd_32:
    ds_read_b128 v[112:115], v104 offset:0
    ds_read_b128 v[116:119], v104 offset:1024
    ds_read_b128 v[120:123], v104 offset:2048
    ds_read_b128 v[124:127], v104 offset:3072
    s_waitcnt lgkmcnt(3)
    v_pk_add_f32 v[16:17], v[16:17], v[112:113]
    v_pk_mul_f32 v[16:17], v[16:17], v[130:131]
    v_pk_fma_f32 v[16:17], v[16:17], v[100:101], v[128:129] op_sel:[0,1,0] op_sel_hi:[1,1,1]
    v_cvt_pk_bf16_f32 v48, v16, v17
    s_add_u32 s60, s76, 0
    buffer_store_dword v48, v9, s[40:43], s60 offen sc1
    v_pk_add_f32 v[18:19], v[18:19], v[114:115]
    v_pk_mul_f32 v[18:19], v[18:19], v[134:135]
    v_pk_fma_f32 v[18:19], v[18:19], v[100:101], v[132:133] op_sel:[0,1,0] op_sel_hi:[1,1,1]
    v_cvt_pk_bf16_f32 v49, v18, v19
    s_add_u32 s60, s76, 32768
    buffer_store_dword v49, v9, s[40:43], s60 offen sc1
    s_waitcnt lgkmcnt(2)
    v_pk_add_f32 v[20:21], v[20:21], v[116:117]
    v_pk_mul_f32 v[20:21], v[20:21], v[138:139]
    v_pk_fma_f32 v[20:21], v[20:21], v[100:101], v[136:137] op_sel:[0,1,0] op_sel_hi:[1,1,1]
    v_cvt_pk_bf16_f32 v50, v20, v21
    s_add_u32 s60, s76, 262144
    buffer_store_dword v50, v9, s[40:43], s60 offen sc1
    v_pk_add_f32 v[22:23], v[22:23], v[118:119]
    v_pk_mul_f32 v[22:23], v[22:23], v[142:143]
    v_pk_fma_f32 v[22:23], v[22:23], v[100:101], v[140:141] op_sel:[0,1,0] op_sel_hi:[1,1,1]
    v_cvt_pk_bf16_f32 v51, v22, v23
    s_add_u32 s60, s76, 294912
    buffer_store_dword v51, v9, s[40:43], s60 offen sc1
    s_waitcnt lgkmcnt(1)
    v_pk_add_f32 v[24:25], v[24:25], v[120:121]
    v_pk_mul_f32 v[24:25], v[24:25], v[146:147]
    v_pk_fma_f32 v[24:25], v[24:25], v[100:101], v[144:145] op_sel:[0,1,0] op_sel_hi:[1,1,1]
    v_cvt_pk_bf16_f32 v52, v24, v25
    s_add_u32 s60, s76, 524288
    buffer_store_dword v52, v9, s[40:43], s60 offen sc1
    v_pk_add_f32 v[26:27], v[26:27], v[122:123]
    v_pk_mul_f32 v[26:27], v[26:27], v[150:151]
    v_pk_fma_f32 v[26:27], v[26:27], v[100:101], v[148:149] op_sel:[0,1,0] op_sel_hi:[1,1,1]
    v_cvt_pk_bf16_f32 v53, v26, v27
    s_add_u32 s60, s76, 557056
    buffer_store_dword v53, v9, s[40:43], s60 offen sc1
    s_waitcnt lgkmcnt(0)
    v_pk_add_f32 v[28:29], v[28:29], v[124:125]
    v_pk_mul_f32 v[28:29], v[28:29], v[154:155]
    v_pk_fma_f32 v[28:29], v[28:29], v[100:101], v[152:153] op_sel:[0,1,0] op_sel_hi:[1,1,1]
    v_cvt_pk_bf16_f32 v54, v28, v29
    s_add_u32 s60, s76, 786432
    buffer_store_dword v54, v9, s[40:43], s60 offen sc1
    v_pk_add_f32 v[30:31], v[30:31], v[126:127]
    v_pk_mul_f32 v[30:31], v[30:31], v[158:159]
    v_pk_fma_f32 v[30:31], v[30:31], v[100:101], v[156:157] op_sel:[0,1,0] op_sel_hi:[1,1,1]
    v_cvt_pk_bf16_f32 v55, v30, v31
    s_add_u32 s60, s76, 819200
    buffer_store_dword v55, v9, s[40:43], s60 offen sc1
    s_mov_b64 exec, 1
    ds_add_rtn_u32 v6, v3, v5 offset:92
    s_mov_b64 exec, -1
    s_waitcnt vmcnt(0)
    s_mov_b64 exec, 1
    s_waitcnt lgkmcnt(0)
    ds_add_rtn_u32 v6, v3, v5 offset:44
    s_mov_b64 exec, -1
    s_waitcnt lgkmcnt(0)
    v_readfirstlane_b32 s11, v6
    s_cmp_lg_u32 s11, 7
    s_cbranch_scc1 Lar_34
    s_lshl_b32 s60, s6, 7
    s_add_u32 s60, s60, 0x12ee000
    v_lshlrev_b32 v7, 10, v1
    v_add_u32 v7, s60, v7
    s_mov_b64 exec, 0xffff
    global_atomic_add v7, v5, s[4:5] sc1
    s_mov_b64 exec, -1
    v_mov_b32 v6, 1
    ds_write_b32 v3, v6 offset:88
Lar_34:
    s_setprio 0
    s_branch L_main
L_b:
    s_sub_u32 s68, s3, 4
    s_cmp_lg_u32 s3, 4
    s_cbranch_scc1 Lz_35
    s_cmp_ge_u32 s2, 2
    s_cbranch_scc1 Lz_35
    s_lshl_b32 s60, s2, 13
    s_add_u32 s60, s60, 0x12ee000
    s_waitcnt vmcnt(0)
    v_readfirstlane_b32 s100, v127
    s_add_u32 s100, s100, 0x9e3779b9
    s_mov_b32 s101, s100
    v_lshl_add_u32 v8, v1, 7, s60
    v_mov_b32 v9, s100
    global_store_dword v8, v9, s[4:5] sc1
Lz_35:
    s_cmp_lg_u32 s3, 7
    s_cbranch_scc1 Ltp_36
    s_cmp_ge_u32 s7, 4
    s_cbranch_scc1 Ltp_36
    s_mov_b32 s40, s4
    s_mov_b32 s41, s5
    s_mov_b32 s42, 0x1306000
    s_mov_b32 s43, 0x20000
    v_mul_u32_u24 v8, 2097152, v1
    s_mov_b32 s60, 0
    buffer_load_dword v120, v8, s[40:43], s60 offen
    v_lshlrev_b32 v8, 15, v1
    s_mov_b32 s40, s30
    s_mov_b32 s41, s31
    s_mov_b32 s42, 0x1c0000
    s_mov_b32 s43, 0x20000
    s_mov_b32 exec_lo, 0x10001
    s_mov_b32 exec_hi, 0x10001
    buffer_load_dword v121, v8, s[40:43], 0 offen
    s_mov_b64 exec, -1
    s_mov_b32 s40, s32
    s_mov_b32 s41, s33
    s_mov_b32 s42, 0x1c0000
    s_mov_b32 s43, 0x20000
    s_mov_b32 exec_lo, 0x10001
    s_mov_b32 exec_hi, 0x10001
    buffer_load_dword v121, v8, s[40:43], 0 offen
    s_mov_b64 exec, -1
    s_mov_b32 s40, s34
    s_mov_b32 s41, s35
    s_mov_b32 s42, 0x1c0000
    s_mov_b32 s43, 0x20000
    s_mov_b32 exec_lo, 0x10001
    s_mov_b32 exec_hi, 0x10001
    buffer_load_dword v121, v8, s[40:43], 0 offen
    s_mov_b64 exec, -1
    s_mov_b32 s40, s24
    s_mov_b32 s41, s25
    s_mov_b32 s42, 0x200000
    s_mov_b32 s43, 0x20000
    s_mov_b32 exec_lo, 0x10001
    s_mov_b32 exec_hi, 0x10001
    buffer_load_dword v121, v8, s[40:43], 0 offen
    s_mov_b64 exec, -1
Ltp_36:
    s_lshl_b32 s60, s6, 5
    s_add_u32 s60, s60, s7
    s_lshl_b32 s60, s60, 3
    s_lshl_b32 s61, s68, 1
    s_add_u32 s69, s60, s61
    v_lshrrev_b32 v8, 5, v1
    v_and_b32 v9, 31, v1
    v_lshlrev_b32 v10, 10, v8
    v_lshl_add_u32 v10, v9, 4, v10
    s_lshl_b32 s60, s69, 10
    s_mov_b32 s40, s16
    s_mov_b32 s41, s17
    s_mov_b32 s42, 0x200000
    s_mov_b32 s43, 0x20000
    s_mov_b32 s66, 0
Lsp_37:
    ds_read_b32 v6, v3 offset:96
    s_add_u32 s66, s66, 1
    s_cmp_gt_u32 s66, 8000000
    s_waitcnt lgkmcnt(0)
    s_cbranch_scc1 Lsd_38
    v_readfirstlane_b32 s11, v6
    s_cmp_ge_u32 s11, 4
    s_cbranch_scc0 Lsp_37
Lsd_38:
    buffer_load_dwordx4 v[16:19], v10, s[40:43], s60 offen
    buffer_load_dwordx4 v[20:23], v10, s[40:43], s60 offen offset:512
    s_and_b32 s70, s2, 3
    s_lshr_b32 s71, s2, 2
    s_lshl_b32 s60, s70, 7
    s_lshl_b32 s61, s68, 5
    s_add_u32 s60, s60, s61
    v_lshrrev_b32 v11, 3, v1
    v_lshl_add_u32 v11, v11, 2, s60
    v_mul_u32_u24 v12, 6144, v11
    v_and_b32 v13, 7, v1
    v_lshl_add_u32 v12, v13, 4, v12
    v_lshlrev_b32 v11, 1, v11
    s_cmp_lt_u32 s2, 192
    s_cselect_b32 s62, 0x300000, 0
    s_cselect_b32 s72, 0x18000, 0
    s_mov_b32 s44, s38
    s_mov_b32 s45, s39
    s_mov_b32 s46, s62
    s_mov_b32 s47, 0x20000
    s_mov_b32 s48, s36
    s_mov_b32 s49, s37
    s_mov_b32 s50, 0x400
    s_mov_b32 s51, 0x20000
    s_lshl_b32 s60, s71, 7
    buffer_load_dwordx4 v[24:27], v12, s[44:47], s60 offen
    s_add_u32 s60, s60, 6144
    buffer_load_dwordx4 v[28:31], v12, s[44:47], s60 offen
    s_add_u32 s60, s60, 6144
    buffer_load_dwordx4 v[32:35], v12, s[44:47], s60 offen
    s_add_u32 s60, s60, 6144
    buffer_load_dwordx4 v[36:39], v12, s[44:47], s60 offen
    buffer_load_dwordx2 v[42:43], v11, s[48:51], 0 offen
    s_lshr_b32 s73, s68, 1
    s_and_b32 s74, s68, 1
    s_lshl_b32 s75, s8, 1
    s_add_u32 s75, s75, s74
    s_cmp_eq_u32 s73, 0
    s_cselect_b32 s60, s30, s32
    s_cselect_b32 s61, s31, s33
    s_mov_b32 s56, s60
    s_mov_b32 s57, s61
    s_mov_b32 s58, 0x1c0000
    s_mov_b32 s59, 0x20000
    s_mul_i32 s80, s75, 57344
    s_mul_i32 s61, s9, 224
    s_add_u32 s80, s80, s61
    v_mov_b32 v44, 0
    v_mov_b32 v45, 0
    v_mov_b32 v46, 0
    v_mov_b32 v47, 0
    s_waitcnt vmcnt(7)
    v_readfirstlane_b32 s100, v127
    s_add_u32 s100, s100, 0x9e3779b9
    s_mov_b32 s101, s100
    s_mov_b32 s63, 0x3f803f80
    s_waitcnt vmcnt(6)
    v_dot2c_f32_bf16 v44, s63, v16
    v_dot2c_f32_bf16 v46, v16, v16
    v_dot2c_f32_bf16 v45, s63, v17
    v_dot2c_f32_bf16 v47, v17, v17
    v_dot2c_f32_bf16 v44, s63, v18
    v_dot2c_f32_bf16 v46, v18, v18
    v_dot2c_f32_bf16 v45, s63, v19
    v_dot2c_f32_bf16 v47, v19, v19
    s_waitcnt vmcnt(5)
    v_dot2c_f32_bf16 v44, s63, v20
    v_dot2c_f32_bf16 v46, v20, v20
    v_dot2c_f32_bf16 v45, s63, v21
    v_dot2c_f32_bf16 v47, v21, v21
    v_dot2c_f32_bf16 v44, s63, v22
    v_dot2c_f32_bf16 v46, v22, v22
    v_dot2c_f32_bf16 v45, s63, v23
    v_dot2c_f32_bf16 v47, v23, v23
    s_nop 1
    v_add_f32 v44, v44, v45
    v_add_f32 v46, v46, v47
    s_nop 0
    v_add_f32_dpp v44, v44, v44 quad_perm:[1,0,3,2] row_mask:0xf bank_mask:0xf
    v_add_f32_dpp v46, v46, v46 quad_perm:[1,0,3,2] row_mask:0xf bank_mask:0xf
    s_nop 0
    v_add_f32_dpp v44, v44, v44 quad_perm:[2,3,0,1] row_mask:0xf bank_mask:0xf
    v_add_f32_dpp v46, v46, v46 quad_perm:[2,3,0,1] row_mask:0xf bank_mask:0xf
    s_nop 0
    v_add_f32_dpp v44, v44, v44 row_half_mirror row_mask:0xf bank_mask:0xf
    v_add_f32_dpp v46, v46, v46 row_half_mirror row_mask:0xf bank_mask:0xf
    s_nop 0
    v_add_f32_dpp v44, v44, v44 row_mirror row_mask:0xf bank_mask:0xf
    v_add_f32_dpp v46, v46, v46 row_mirror row_mask:0xf bank_mask:0xf
    s_nop 0
    v_add_f32_dpp v44, v44, v44 row_bcast:15 row_mask:0xa bank_mask:0xf
    v_add_f32_dpp v46, v46, v46 row_bcast:15 row_mask:0xa bank_mask:0xf
    v_mul_f32 v44, 0x3b000000, v44
    v_mul_f32 v46, 0x3b000000, v46
    v_fma_f32 v46, -v44, v44, v46
    v_max_f32 v46, 0, v46
    v_add_f32 v46, 0x3727c5ac, v46
    v_rsq_f32 v46, v46
    s_add_u32 s40, s4, 0x410000
    s_addc_u32 s41, s5, 0
    s_mov_b32 s42, 0x4000
    s_mov_b32 s43, 0x20000
    v_lshlrev_b32 v8, 3, v8
    s_lshl_b32 s60, s69, 3
    v_mul_f32 v47, v44, v46
    v_sub_f32 v47, 0, v47
    s_mov_b32 exec_lo, 0x10000
    s_mov_b32 exec_hi, 0x10000
    buffer_store_dwordx2 v[46:47], v8, s[40:43], s60 offen sc1
    s_mov_b64 exec, -1
    v_lshlrev_b32 v8, 2, v1
    s_waitcnt vmcnt(1)
    v_lshlrev_b32 v40, 16, v42
    v_mul_f32 v72, 0xbfb8aa3b, v40
    v_exp_f32 v72, v72
    s_nop 0
    v_add_f32 v72, 1.0, v72
    v_rcp_f32 v72, v72
    s_nop 0
    v_mul_f32 v40, v40, v72
    v_cvt_pk_bf16_f32 v40, v40, v40
    v_and_b32 v40, s10, v40
    v_and_b32 v41, s10, v42
    v_mul_f32 v72, 0xbfb8aa3b, v41
    v_exp_f32 v72, v72
    s_nop 0
    v_add_f32 v72, 1.0, v72
    v_rcp_f32 v72, v72
    s_nop 0
    v_mul_f32 v41, v41, v72
    v_cvt_pk_bf16_f32 v41, v41, v41
    v_and_b32 v41, s10, v41
    v_lshlrev_b32 v42, 16, v43
    v_mul_f32 v72, 0xbfb8aa3b, v42
    v_exp_f32 v72, v72
    s_nop 0
    v_add_f32 v72, 1.0, v72
    v_rcp_f32 v72, v72
    s_nop 0
    v_mul_f32 v42, v42, v72
    v_cvt_pk_bf16_f32 v42, v42, v42
    v_and_b32 v42, s10, v42
    v_and_b32 v43, s10, v43
    v_mul_f32 v72, 0xbfb8aa3b, v43
    v_exp_f32 v72, v72
    s_nop 0
    v_add_f32 v72, 1.0, v72
    v_rcp_f32 v72, v72
    s_nop 0
    v_mul_f32 v43, v43, v72
    v_cvt_pk_bf16_f32 v43, v43, v43
    v_and_b32 v43, s10, v43
    v_lshlrev_b32 v88, 16, v24
    v_and_b32 v89, s10, v24
    v_pk_mul_f32 v[80:81], v[88:89], v[40:41] op_sel:[0,0] op_sel_hi:[1,0]
    v_lshlrev_b32 v88, 16, v25
    v_and_b32 v89, s10, v25
    v_pk_mul_f32 v[82:83], v[88:89], v[40:41] op_sel:[0,0] op_sel_hi:[1,0]
    v_lshlrev_b32 v88, 16, v26
    v_and_b32 v89, s10, v26
    v_pk_mul_f32 v[84:85], v[88:89], v[40:41] op_sel:[0,0] op_sel_hi:[1,0]
    v_lshlrev_b32 v88, 16, v27
    v_and_b32 v89, s10, v27
    v_pk_mul_f32 v[86:87], v[88:89], v[40:41] op_sel:[0,0] op_sel_hi:[1,0]
    v_lshlrev_b32 v88, 16, v28
    v_and_b32 v89, s10, v28
    v_pk_fma_f32 v[80:81], v[88:89], v[40:41], v[80:81] op_sel:[0,1,0] op_sel_hi:[1,1,1]
    v_lshlrev_b32 v88, 16, v29
    v_and_b32 v89, s10, v29
    v_pk_fma_f32 v[82:83], v[88:89], v[40:41], v[82:83] op_sel:[0,1,0] op_sel_hi:[1,1,1]
    v_lshlrev_b32 v88, 16, v30
    v_and_b32 v89, s10, v30
    v_pk_fma_f32 v[84:85], v[88:89], v[40:41], v[84:85] op_sel:[0,1,0] op_sel_hi:[1,1,1]
    v_lshlrev_b32 v88, 16, v31
    v_and_b32 v89, s10, v31
    v_pk_fma_f32 v[86:87], v[88:89], v[40:41], v[86:87] op_sel:[0,1,0] op_sel_hi:[1,1,1]
    v_lshlrev_b32 v88, 16, v32
    v_and_b32 v89, s10, v32
    v_pk_fma_f32 v[80:81], v[88:89], v[42:43], v[80:81] op_sel:[0,0,0] op_sel_hi:[1,0,1]
    v_lshlrev_b32 v88, 16, v33
    v_and_b32 v89, s10, v33
    v_pk_fma_f32 v[82:83], v[88:89], v[42:43], v[82:83] op_sel:[0,0,0] op_sel_hi:[1,0,1]
    v_lshlrev_b32 v88, 16, v34
    v_and_b32 v89, s10, v34
    v_pk_fma_f32 v[84:85], v[88:89], v[42:43], v[84:85] op_sel:[0,0,0] op_sel_hi:[1,0,1]
    v_lshlrev_b32 v88, 16, v35
    v_and_b32 v89, s10, v35
    v_pk_fma_f32 v[86:87], v[88:89], v[42:43], v[86:87] op_sel:[0,0,0] op_sel_hi:[1,0,1]
    v_lshlrev_b32 v88, 16, v36
    v_and_b32 v89, s10, v36
    v_pk_fma_f32 v[80:81], v[88:89], v[42:43], v[80:81] op_sel:[0,1,0] op_sel_hi:[1,1,1]
    v_lshlrev_b32 v88, 16, v37
    v_and_b32 v89, s10, v37
    v_pk_fma_f32 v[82:83], v[88:89], v[42:43], v[82:83] op_sel:[0,1,0] op_sel_hi:[1,1,1]
    v_lshlrev_b32 v88, 16, v38
    v_and_b32 v89, s10, v38
    v_pk_fma_f32 v[84:85], v[88:89], v[42:43], v[84:85] op_sel:[0,1,0] op_sel_hi:[1,1,1]
    v_lshlrev_b32 v88, 16, v39
    v_and_b32 v89, s10, v39
    v_pk_fma_f32 v[86:87], v[88:89], v[42:43], v[86:87] op_sel:[0,1,0] op_sel_hi:[1,1,1]
    v_add_f32_dpp v80, v80, v80 row_ror:8 row_mask:0xf bank_mask:0xf
    v_add_f32_dpp v81, v81, v81 row_ror:8 row_mask:0xf bank_mask:0xf
    v_add_f32_dpp v82, v82, v82 row_ror:8 row_mask:0xf bank_mask:0xf
    v_add_f32_dpp v83, v83, v83 row_ror:8 row_mask:0xf bank_mask:0xf
    v_add_f32_dpp v84, v84, v84 row_ror:8 row_mask:0xf bank_mask:0xf
    v_add_f32_dpp v85, v85, v85 row_ror:8 row_mask:0xf bank_mask:0xf
    v_add_f32_dpp v86, v86, v86 row_ror:8 row_mask:0xf bank_mask:0xf
    v_add_f32_dpp v87, v87, v87 row_ror:8 row_mask:0xf bank_mask:0xf
    v_lshrrev_b32 v9, 4, v1
    s_lshl_b32 s61, s68, 2
    v_add_u32 v9, s61, v9
    v_lshlrev_b32 v9, 8, v9
    v_lshl_add_u32 v9, v13, 5, v9
    v_add_u32 v9, 0x26200, v9
    s_mov_b32 exec_lo, 0x00ff00ff
    s_mov_b32 exec_hi, 0x00ff00ff
    ds_write_b128 v9, v[80:83]
    ds_write_b128 v9, v[84:87] offset:16
    s_mov_b64 exec, -1
    s_add_u32 s44, s4, 0x414000
    s_addc_u32 s45, s5, 0
    s_mov_b32 s46, s72
    s_mov_b32 s47, 0x20000
    s_mov_b64 exec, 1
    ds_add_rtn_u32 v6, v3, v5 offset:8
    s_mov_b64 exec, -1
    s_waitcnt lgkmcnt(0)
    v_readfirstlane_b32 s11, v6
    s_cmp_lg_u32 s11, 3
    s_cbranch_scc1 Lar_39
    v_lshl_add_u32 v9, v1, 2, v3
    ds_read_b32 v96, v9 offset:8704
    ds_read_b32 v97, v9 offset:8960
    ds_read_b32 v98, v9 offset:9216
    ds_read_b32 v99, v9 offset:9472
    ds_read_b32 v100, v9 offset:9728
    ds_read_b32 v101, v9 offset:9984
    ds_read_b32 v102, v9 offset:10240
    ds_read_b32 v103, v9 offset:10496
    ds_read_b32 v104, v9 offset:10752
    ds_read_b32 v105, v9 offset:11008
    ds_read_b32 v106, v9 offset:11264
    ds_read_b32 v107, v9 offset:11520
    ds_read_b32 v108, v9 offset:11776
    ds_read_b32 v109, v9 offset:12032
    ds_read_b32 v110, v9 offset:12288
    ds_read_b32 v111, v9 offset:12544
    s_waitcnt lgkmcnt(7)
    v_add_f32 v96, v96, v104
    s_waitcnt lgkmcnt(6)
    v_add_f32 v97, v97, v105
    s_waitcnt lgkmcnt(5)
    v_add_f32 v98, v98, v106
    s_waitcnt lgkmcnt(4)
    v_add_f32 v99, v99, v107
    s_waitcnt lgkmcnt(3)
    v_add_f32 v100, v100, v108
    s_waitcnt lgkmcnt(2)
    v_add_f32 v101, v101, v109
    s_waitcnt lgkmcnt(1)
    v_add_f32 v102, v102, v110
    s_waitcnt lgkmcnt(0)
    v_add_f32 v103, v103, v111
    v_add_f32 v96, v96, v100
    v_add_f32 v97, v97, v101
    v_add_f32 v98, v98, v102
    v_add_f32 v99, v99, v103
    v_add_f32 v96, v96, v98
    v_add_f32 v97, v97, v99
    v_add_f32 v96, v96, v97
    s_mul_i32 s61, s70, 24576
    s_lshl_b32 s62, s71, 9
    s_add_u32 s61, s61, s62
    v_mov_b32 v97, s100
    v_lshlrev_b32 v9, 3, v1
    buffer_store_dwordx2 v[96:97], v9, s[44:47], s61 offen sc1
Lar_39:
    v_lshrrev_b32 v116, 4, v1
    v_and_b32 v117, 15, v1
    v_lshlrev_b32 v117, 4, v117
    v_mul_u32_u24 v118, 3584, v116
    v_add_u32 v118, v118, v117
    s_mul_i32 s81, s68, 6144
    s_add_u32 s81, s81, 95232
    s_add_u32 m0, s81, 0
    s_nop 0
    buffer_load_dwordx4 v118, s[56:59], s80 offen lds
    s_add_u32 s80, s80, 4*3584
    s_add_u32 m0, s81, 1024
    s_nop 0
    buffer_load_dwordx4 v118, s[56:59], s80 offen lds
    s_add_u32 s80, s80, 4*3584
    s_add_u32 m0, s81, 2048
    s_nop 0
    buffer_load_dwordx4 v118, s[56:59], s80 offen lds
    s_add_u32 s80, s80, 4*3584
    s_add_u32 m0, s81, 3072
    s_nop 0
    buffer_load_dwordx4 v118, s[56:59], s80 offen lds
    s_cmp_lt_u32 s2, 224
    s_cselect_b32 s62, 0x1c0000, 0
    s_mov_b32 s52, s34
    s_mov_b32 s53, s35
    s_mov_b32 s54, s62
    s_mov_b32 s55, 0x20000
    v_lshl_add_u32 v118, v116, 10, v117
    s_lshl_b32 s60, s68, 8
    s_lshl_b32 s61, s2, 13
    s_add_u32 s60, s60, s61
    s_add_u32 s61, s60, 4096
    s_add_u32 m0, s81, 4096
    s_nop 0
    buffer_load_dwordx4 v118, s[52:55], s60 offen lds
    s_add_u32 m0, s81, 5120
    s_nop 0
    buffer_load_dwordx4 v118, s[52:55], s61 offen lds
    s_add_u32 s52, s4, 0xa1c000
    s_addc_u32 s53, s5, 0
    s_mov_b32 s54, s62
    s_mov_b32 s55, 0x20000
    s_waitcnt vmcnt(6)
    s_mov_b64 exec, 1
    ds_add_rtn_u32 v6, v3, v5 offset:4
    s_mov_b64 exec, -1
    s_waitcnt lgkmcnt(0)
    v_readfirstlane_b32 s11, v6
    s_cmp_lg_u32 s11, 7
    s_cbranch_scc1 Lar_40
    s_lshl_b32 s60, s6, 7
    s_lshl_b32 s61, s7, 2
    s_add_u32 s60, s60, s61
    s_add_u32 s60, s60, 0x12de000
    v_mul_u32_u24 v7, 1024, v1
    v_add_u32 v7, s60, v7
    v_mov_b32 v6, s100
    s_mov_b64 exec, 0xffff
    global_atomic_swap v7, v6, s[4:5] sc1
    s_mov_b64 exec, -1
Lar_40:
    v_lshrrev_b32 v11, 3, v1
    s_lshl_b32 s60, s73, 4
    v_add_u32 v12, s60, v13
    v_lshl_add_u32 v14, v11, 5, v12
    v_lshl_add_u32 v14, v14, 3, v3
    s_lshl_b32 s60, s74, 11
    v_add_u32 v14, s60, v14
    v_lshlrev_b32 v12, 4, v12
    v_lshl_add_u32 v12, v11, 15, v12
    v_and_b32 v11, 3, v1
    v_mul_u32_u24 v11, 24576, v11
    v_and_b32 v15, 60, v1
    v_lshl_add_u32 v11, v15, 1, v11
    s_lshl_b32 s77, s75, 7
    s_add_u32 s78, s77, 16384
    s_add_u32 s77, s77, 12288
    s_add_u32 s44, s4, 0x414000
    s_addc_u32 s45, s5, 0
    s_mov_b32 s46, 0x18000
    s_mov_b32 s47, 0x20000
    s_mul_i32 s60, s9, 7*32768
    s_add_u32 s40, s4, 0x62c000
    s_addc_u32 s41, s5, 0
    s_add_u32 s40, s40, s60
    s_addc_u32 s41, s41, 0
    s_mov_b32 s42, 0x38000
    s_mov_b32 s43, 0x20000
    s_lshl_b32 s79, s75, 10
    v_lshl_add_u32 v9, v1, 2, s81
    s_waitcnt vmcnt(0)
    ds_read_b32 v48, v9 offset:0
    ds_read_b32 v49, v9 offset:256
    ds_read_b32 v50, v9 offset:512
    ds_read_b32 v51, v9 offset:768
    ds_read_b32 v52, v9 offset:1024
    ds_read_b32 v53, v9 offset:1280
    ds_read_b32 v54, v9 offset:1536
    ds_read_b32 v55, v9 offset:1792
    ds_read_b32 v56, v9 offset:2048
    ds_read_b32 v57, v9 offset:2304
    ds_read_b32 v58, v9 offset:2560
    ds_read_b32 v59, v9 offset:2816
    ds_read_b32 v60, v9 offset:3072
    ds_read_b32 v61, v9 offset:3328
    ds_read_b32 v62, v9 offset:3584
    ds_read_b32 v63, v9 offset:3840
    ds_read_b32 v64, v9 offset:4096
    ds_read_b32 v65, v9 offset:4352
    ds_read_b32 v66, v9 offset:4608
    ds_read_b32 v67, v9 offset:4864
    ds_read_b32 v68, v9 offset:5120
    ds_read_b32 v69, v9 offset:5376
    ds_read_b32 v70, v9 offset:5632
    ds_read_b32 v71, v9 offset:5888
    s_waitcnt lgkmcnt(15)
    v_lshlrev_b32 v96, 16, v48
    v_and_b32 v97, s10, v48
    v_lshlrev_b32 v98, 16, v49
    v_and_b32 v99, s10, v49
    v_lshlrev_b32 v100, 16, v50
    v_and_b32 v101, s10, v50
    v_lshlrev_b32 v102, 16, v51
    v_and_b32 v103, s10, v51
    v_lshlrev_b32 v104, 16, v52
    v_and_b32 v105, s10, v52
    v_lshlrev_b32 v106, 16, v53
    v_and_b32 v107, s10, v53
    v_lshlrev_b32 v108, 16, v54
    v_and_b32 v109, s10, v54
    v_lshlrev_b32 v110, 16, v55
    v_and_b32 v111, s10, v55
    v_lshlrev_b32 v112, 16, v56
    v_and_b32 v113, s10, v56
    s_waitcnt lgkmcnt(14)
    v_lshlrev_b32 v114, 16, v57
    v_and_b32 v115, s10, v57
    s_waitcnt lgkmcnt(13)
    v_lshlrev_b32 v116, 16, v58
    v_and_b32 v117, s10, v58
    s_waitcnt lgkmcnt(12)
    v_lshlrev_b32 v118, 16, v59
    v_and_b32 v119, s10, v59
    s_waitcnt lgkmcnt(11)
    v_lshlrev_b32 v120, 16, v60
    v_and_b32 v121, s10, v60
    s_waitcnt lgkmcnt(10)
    v_lshlrev_b32 v122, 16, v61
    v_and_b32 v123, s10, v61
    s_waitcnt lgkmcnt(9)
    v_lshlrev_b32 v124, 16, v62
    v_and_b32 v125, s10, v62
    s_waitcnt lgkmcnt(8)
    v_lshlrev_b32 v126, 16, v63
    v_and_b32 v127, s10, v63
    s_mov_b32 s60, 0x05040100
    s_mov_b32 s61, 0x07060302
    s_waitcnt lgkmcnt(6)
    v_perm_b32 v72, v65, v64, s60
    v_perm_b32 v76, v65, v64, s61
    s_waitcnt lgkmcnt(4)
    v_perm_b32 v73, v67, v66, s60
    v_perm_b32 v77, v67, v66, s61
    s_waitcnt lgkmcnt(2)
    v_perm_b32 v74, v69, v68, s60
    v_perm_b32 v78, v69, v68, s61
    s_waitcnt lgkmcnt(0)
    v_perm_b32 v75, v71, v70, s60
    v_perm_b32 v79, v71, v70, s61
    v_lshrrev_b32 v10, 5, v1
    v_mul_u32_u24 v10, 229376, v10
    v_bfe_u32 v15, v1, 3, 2
    v_lshl_add_u32 v10, v15, 10, v10
    v_lshl_add_u32 v10, v13, 4, v10
    s_mul_i32 s64, s68, 458752
    s_lshl_b32 s60, s71, 12
    s_add_u32 s64, s64, s60
    s_lshl_b32 s60, s70, 8
    s_add_u32 s64, s64, s60
    s_mov_b32 s11, 0
Lmp_41:
    buffer_load_dwordx2 v[80:81], v11, s[44:47], s78 offen sc1
    buffer_load_dwordx2 v[82:83], v11, s[44:47], s77 offen sc1
    s_add_u32 s11, s11, 1
    s_waitcnt vmcnt(0)
    s_cmp_gt_u32 s11, 1000000
    s_cbranch_scc1 Lmd_42
    v_cmp_ne_u32 vcc, s100, v81
    v_cmp_ne_u32 s[82:83], s100, v83
    s_or_b64 vcc, vcc, s[82:83]
    s_cbranch_scc1 Lmp_41
Lmd_42:
    v_mov_b32 v81, v82
    v_add_f32_dpp v80, v80, v80 quad_perm:[1,0,3,2] row_mask:0xf bank_mask:0xf
    s_nop 0
    v_add_f32_dpp v81, v81, v81 quad_perm:[1,0,3,2] row_mask:0xf bank_mask:0xf
    v_add_f32_dpp v80, v80, v80 quad_perm:[2,3,0,1] row_mask:0xf bank_mask:0xf
    s_nop 0
    v_add_f32_dpp v81, v81, v81 quad_perm:[2,3,0,1] row_mask:0xf bank_mask:0xf
    v_cvt_pk_bf16_f32 v80, v80, v80
    v_and_b32 v80, s10, v80
    v_cvt_pk_bf16_f32 v81, v81, v81
    v_and_b32 v81, s10, v81
    v_add_f32 v80, 1.0, v80
    v_cvt_pk_bf16_f32 v80, v80, v80
    v_and_b32 v80, s10, v80
    s_mov_b32 s65, s79
    v_readlane_b32 s68, v80, 0
    v_readlane_b32 s69, v80, 4
    v_readlane_b32 s70, v80, 8
    v_readlane_b32 s71, v80, 12
    v_readlane_b32 s72, v80, 16
    v_readlane_b32 s73, v80, 20
    v_readlane_b32 s74, v80, 24
    v_readlane_b32 s75, v80, 28
    v_readlane_b32 s76, v80, 32
    v_readlane_b32 s77, v80, 36
    v_readlane_b32 s78, v80, 40
    v_readlane_b32 s79, v80, 44
    v_readlane_b32 s80, v80, 48
    v_readlane_b32 s81, v80, 52
    v_readlane_b32 s82, v80, 56
    v_readlane_b32 s83, v80, 60
    v_mul_f32 v88, s68, v96
    v_mul_f32 v89, s68, v97
    v_mul_f32 v90, s69, v98
    v_mul_f32 v91, s69, v99
    v_cvt_pk_bf16_f32 v48, v88, v90
    v_cvt_pk_bf16_f32 v52, v89, v91
    v_mul_f32 v88, s70, v100
    v_mul_f32 v89, s70, v101
    v_mul_f32 v90, s71, v102
    v_mul_f32 v91, s71, v103
    v_cvt_pk_bf16_f32 v49, v88, v90
    v_cvt_pk_bf16_f32 v53, v89, v91
    v_mul_f32 v88, s72, v104
    v_mul_f32 v89, s72, v105
    v_mul_f32 v90, s73, v106
    v_mul_f32 v91, s73, v107
    v_cvt_pk_bf16_f32 v50, v88, v90
    v_cvt_pk_bf16_f32 v54, v89, v91
    v_mul_f32 v88, s74, v108
    v_mul_f32 v89, s74, v109
    v_mul_f32 v90, s75, v110
    v_mul_f32 v91, s75, v111
    v_cvt_pk_bf16_f32 v51, v88, v90
    v_cvt_pk_bf16_f32 v55, v89, v91
    buffer_store_dwordx4 v[48:51], v12, s[40:43], s65 offen offset:0 sc1
    buffer_store_dwordx4 v[52:55], v12, s[40:43], s65 offen offset:128 sc1
    v_mul_f32 v88, s76, v112
    v_mul_f32 v89, s76, v113
    v_mul_f32 v90, s77, v114
    v_mul_f32 v91, s77, v115
    v_cvt_pk_bf16_f32 v56, v88, v90
    v_cvt_pk_bf16_f32 v60, v89, v91
    v_mul_f32 v88, s78, v116
    v_mul_f32 v89, s78, v117
    v_mul_f32 v90, s79, v118
    v_mul_f32 v91, s79, v119
    v_cvt_pk_bf16_f32 v57, v88, v90
    v_cvt_pk_bf16_f32 v61, v89, v91
    v_mul_f32 v88, s80, v120
    v_mul_f32 v89, s80, v121
    v_mul_f32 v90, s81, v122
    v_mul_f32 v91, s81, v123
    v_cvt_pk_bf16_f32 v58, v88, v90
    v_cvt_pk_bf16_f32 v62, v89, v91
    v_mul_f32 v88, s82, v124
    v_mul_f32 v89, s82, v125
    v_mul_f32 v90, s83, v126
    v_mul_f32 v91, s83, v127
    v_cvt_pk_bf16_f32 v59, v88, v90
    v_cvt_pk_bf16_f32 v63, v89, v91
    buffer_store_dwordx4 v[56:59], v12, s[40:43], s65 offen offset:512 sc1
    buffer_store_dwordx4 v[60:63], v12, s[40:43], s65 offen offset:640 sc1
    v_readlane_b32 s84, v81, 0
    v_readlane_b32 s85, v81, 4
    v_readlane_b32 s86, v81, 8
    v_readlane_b32 s87, v81, 12
    v_readlane_b32 s88, v81, 16
    v_readlane_b32 s89, v81, 20
    v_readlane_b32 s90, v81, 24
    v_readlane_b32 s91, v81, 28
    v_readlane_b32 s92, v81, 32
    v_readlane_b32 s93, v81, 36
    v_readlane_b32 s94, v81, 40
    v_readlane_b32 s95, v81, 44
    v_readlane_b32 s96, v81, 48
    v_readlane_b32 s97, v81, 52
    v_readlane_b32 s98, v81, 56
    v_readlane_b32 s99, v81, 60
    v_mov_b32 v82, 0
    v_mov_b32 v83, 0
    v_mov_b32 v84, 0
    v_mov_b32 v85, 0
    v_mov_b32 v86, 0
    v_mov_b32 v87, 0
    v_lshlrev_b32 v88, 16, v48
    v_and_b32 v89, s10, v48
    v_lshlrev_b32 v90, 16, v52
    v_and_b32 v91, s10, v52
    v_add_f32 v84, v84, v88
    v_add_f32 v85, v85, v89
    v_add_f32 v86, v86, v90
    v_add_f32 v87, v87, v91
    v_fmac_f32 v82, s84, v96
    v_fmac_f32 v83, s84, v97
    v_fmac_f32 v82, s85, v98
    v_fmac_f32 v83, s85, v99
    v_lshlrev_b32 v88, 16, v49
    v_and_b32 v89, s10, v49
    v_lshlrev_b32 v90, 16, v53
    v_and_b32 v91, s10, v53
    v_add_f32 v84, v84, v88
    v_add_f32 v85, v85, v89
    v_add_f32 v86, v86, v90
    v_add_f32 v87, v87, v91
    v_fmac_f32 v82, s86, v100
    v_fmac_f32 v83, s86, v101
    v_fmac_f32 v82, s87, v102
    v_fmac_f32 v83, s87, v103
    v_lshlrev_b32 v88, 16, v50
    v_and_b32 v89, s10, v50
    v_lshlrev_b32 v90, 16, v54
    v_and_b32 v91, s10, v54
    v_add_f32 v84, v84, v88
    v_add_f32 v85, v85, v89
    v_add_f32 v86, v86, v90
    v_add_f32 v87, v87, v91
    v_fmac_f32 v82, s88, v104
    v_fmac_f32 v83, s88, v105
    v_fmac_f32 v82, s89, v106
    v_fmac_f32 v83, s89, v107
    v_lshlrev_b32 v88, 16, v51
    v_and_b32 v89, s10, v51
    v_lshlrev_b32 v90, 16, v55
    v_and_b32 v91, s10, v55
    v_add_f32 v84, v84, v88
    v_add_f32 v85, v85, v89
    v_add_f32 v86, v86, v90
    v_add_f32 v87, v87, v91
    v_fmac_f32 v82, s90, v108
    v_fmac_f32 v83, s90, v109
    v_fmac_f32 v82, s91, v110
    v_fmac_f32 v83, s91, v111
    v_lshlrev_b32 v88, 16, v56
    v_and_b32 v89, s10, v56
    v_lshlrev_b32 v90, 16, v60
    v_and_b32 v91, s10, v60
    v_add_f32 v84, v84, v88
    v_add_f32 v85, v85, v89
    v_add_f32 v86, v86, v90
    v_add_f32 v87, v87, v91
    v_fmac_f32 v82, s92, v112
    v_fmac_f32 v83, s92, v113
    v_fmac_f32 v82, s93, v114
    v_fmac_f32 v83, s93, v115
    v_lshlrev_b32 v88, 16, v57
    v_and_b32 v89, s10, v57
    v_lshlrev_b32 v90, 16, v61
    v_and_b32 v91, s10, v61
    v_add_f32 v84, v84, v88
    v_add_f32 v85, v85, v89
    v_add_f32 v86, v86, v90
    v_add_f32 v87, v87, v91
    v_fmac_f32 v82, s94, v116
    v_fmac_f32 v83, s94, v117
    v_fmac_f32 v82, s95, v118
    v_fmac_f32 v83, s95, v119
    v_lshlrev_b32 v88, 16, v58
    v_and_b32 v89, s10, v58
    v_lshlrev_b32 v90, 16, v62
    v_and_b32 v91, s10, v62
    v_add_f32 v84, v84, v88
    v_add_f32 v85, v85, v89
    v_add_f32 v86, v86, v90
    v_add_f32 v87, v87, v91
    v_fmac_f32 v82, s96, v120
    v_fmac_f32 v83, s96, v121
    v_fmac_f32 v82, s97, v122
    v_fmac_f32 v83, s97, v123
    v_lshlrev_b32 v88, 16, v59
    v_and_b32 v89, s10, v59
    v_lshlrev_b32 v90, 16, v63
    v_and_b32 v91, s10, v63
    v_add_f32 v84, v84, v88
    v_add_f32 v85, v85, v89
    v_add_f32 v86, v86, v90
    v_add_f32 v87, v87, v91
    v_fmac_f32 v82, s98, v124
    v_fmac_f32 v83, s98, v125
    v_fmac_f32 v82, s99, v126
    v_fmac_f32 v83, s99, v127
    v_add_f32 v84, v84, v85
    v_add_f32 v86, v86, v87
    v_mov_b32 v85, v82
    v_mov_b32 v87, v83
    ds_write_b64 v14, v[84:85] offset:4608
    ds_write_b64 v14, v[86:87] offset:4672
    s_lshl_b32 s60, s9, 3
    s_lshr_b32 s61, s8, 1
    s_add_u32 s60, s60, s61
    s_mul_i32 s60, s60, 3584
    s_and_b32 s61, s8, 1
    s_lshl_b32 s61, s61, 3
    s_add_u32 s60, s60, s61
    s_add_u32 s48, s4, 0x9ac000
    s_addc_u32 s49, s5, 0
    s_add_u32 s48, s48, s60
    s_addc_u32 s49, s49, 0
    s_mov_b32 s50, 0xdf8
    s_mov_b32 s51, 0x20000
    s_lshl_b32 s60, s9, 9
    s_lshl_b32 s61, s8, 2
    s_add_u32 s60, s60, s61
    s_add_u32 s60, s60, 0x12e2000
    s_waitcnt vmcnt(0)
    s_mov_b64 exec, 1
    ds_add_rtn_u32 v6, v3, v5 offset:36
    s_mov_b64 exec, -1
    s_waitcnt lgkmcnt(0)
    v_readfirstlane_b32 s11, v6
    s_cmp_lg_u32 s11, 3
    s_cbranch_scc1 Lar_43
    v_mul_u32_u24 v7, 128, v1
    v_add_u32 v7, s60, v7
    v_mov_b32 v6, s100
    s_mov_b64 exec, 0xf
    global_atomic_swap v7, v6, s[4:5] sc1
    s_mov_b64 exec, -1
    v_add_u32 v9, v3, v4
    ds_read_b128 v[96:99], v9 offset:4608
    ds_read_b128 v[100:103], v9 offset:5632
    ds_read_b128 v[104:107], v9 offset:6656
    ds_read_b128 v[108:111], v9 offset:7680
    s_waitcnt lgkmcnt(1)
    v_add_f32 v88, v96, v104
    v_add_f32 v89, v97, v105
    v_add_f32 v90, v98, v106
    v_add_f32 v91, v99, v107
    s_waitcnt lgkmcnt(0)
    v_add_f32 v92, v100, v108
    v_add_f32 v93, v101, v109
    v_add_f32 v94, v102, v110
    v_add_f32 v95, v103, v111
    v_lshlrev_b32 v9, 5, v1
    buffer_store_dwordx2 v[88:89], v9, s[48:51], 0 offen offset:0 sc1
    buffer_store_dwordx2 v[90:91], v9, s[48:51], 0 offen offset:16 sc1
    buffer_store_dwordx2 v[92:93], v9, s[48:51], 0 offen offset:2048 sc1
    buffer_store_dwordx2 v[94:95], v9, s[48:51], 0 offen offset:2064 sc1
Lar_43:
    s_setprio 0
    buffer_store_dwordx4 v[72:75], v10, s[52:55], s64 offen sc1
    buffer_store_dwordx4 v[76:79], v10, s[52:55], s64 offen offset:128 sc1
    s_waitcnt vmcnt(0)
    s_mov_b64 exec, 1
    ds_add_rtn_u32 v6, v3, v5 offset:44
    s_mov_b64 exec, -1
    s_waitcnt lgkmcnt(0)
    v_readfirstlane_b32 s11, v6
    s_cmp_lg_u32 s11, 7
    s_cbranch_scc1 Lar_44
    s_lshl_b32 s60, s6, 7
    s_add_u32 s60, s60, 0x12ee000
    v_lshlrev_b32 v7, 10, v1
    v_add_u32 v7, s60, v7
    s_mov_b64 exec, 0xffff
    global_atomic_add v7, v5, s[4:5] sc1
    s_mov_b64 exec, -1
    v_mov_b32 v6, 1
    ds_write_b32 v3, v6 offset:88
Lar_44:
    s_cmp_eq_u32 s3, 7
    s_cbranch_scc1 L_help
L_main:
    s_mul_i32 s68, s9, 7
    s_add_u32 s68, s68, s3
    s_lshl_b32 s60, s68, 15
    s_add_u32 s40, s4, 0x62c000
    s_addc_u32 s41, s5, 0
    s_add_u32 s40, s40, s60
    s_addc_u32 s41, s41, 0
    s_mov_b32 s42, 0x8000
    s_mov_b32 s43, 0x20000
    s_lshr_b32 s70, s9, 2
    s_and_b32 s70, s70, 1
    s_and_b32 s71, s9, 3
    s_lshr_b32 s60, s9, 3
    s_lshl_b32 s60, s60, 2
    s_add_u32 s71, s71, s60
    s_mul_i32 s60, s71, 229376
    s_lshl_b32 s61, s3, 15
    s_add_u32 s60, s60, s61
    s_add_u32 s56, s4, 0xa1c000
    s_addc_u32 s57, s5, 0
    s_add_u32 s56, s56, s60
    s_addc_u32 s57, s57, 0
    s_mov_b32 s58, 0x8000
    s_mov_b32 s59, 0x20000
    s_mov_b32 s81, 4096
    s_mov_b32 s82, 8192
    s_mov_b32 s83, 12288
    s_mov_b32 s84, 16384
    s_mov_b32 s85, 20480
    s_mov_b32 s86, 24576
    s_mov_b32 s87, 28672
    s_mov_b32 s89, 0x3b000000
    s_mov_b32 s87, 28672
    s_mov_b32 s66, 0
Lsp_45:
    ds_read_b32 v6, v3 offset:40
    s_add_u32 s66, s66, 1
    s_cmp_gt_u32 s66, 8000000
    s_waitcnt lgkmcnt(0)
    s_cbranch_scc1 Lsd_46
    v_readfirstlane_b32 s11, v6
    s_cmp_ge_u32 s11, 1
    s_cbranch_scc0 Lsp_45
Lsd_46:
    s_cmp_lt_u32 s3, 4
    s_cbranch_scc1 Lwl_47
    s_mov_b32 s66, 0
Lsp_49:
    ds_read_b32 v6, v3 offset:92
    s_add_u32 s66, s66, 1
    s_cmp_gt_u32 s66, 8000000
    s_waitcnt lgkmcnt(0)
    s_cbranch_scc1 Lsd_50
    v_readfirstlane_b32 s11, v6
    s_cmp_ge_u32 s11, 4
    s_cbranch_scc0 Lsp_49
Lsd_50:
    buffer_load_dwordx4 v[128:131], v4, s[40:43], 0 offen offset:0 sc1
    buffer_load_dwordx4 v[132:135], v4, s[40:43], 0 offen offset:1024 sc1
    buffer_load_dwordx4 v[136:139], v4, s[40:43], 0 offen offset:2048 sc1
    buffer_load_dwordx4 v[140:143], v4, s[40:43], 0 offen offset:3072 sc1
    buffer_load_dwordx4 v[144:147], v4, s[40:43], s81 offen offset:0 sc1
    buffer_load_dwordx4 v[148:151], v4, s[40:43], s81 offen offset:1024 sc1
    buffer_load_dwordx4 v[152:155], v4, s[40:43], s81 offen offset:2048 sc1
    buffer_load_dwordx4 v[156:159], v4, s[40:43], s81 offen offset:3072 sc1
    buffer_load_dwordx4 v[160:163], v4, s[40:43], s82 offen offset:0 sc1
    buffer_load_dwordx4 v[164:167], v4, s[40:43], s82 offen offset:1024 sc1
    buffer_load_dwordx4 v[168:171], v4, s[40:43], s82 offen offset:2048 sc1
    buffer_load_dwordx4 v[172:175], v4, s[40:43], s82 offen offset:3072 sc1
    s_mov_b32 s66, 0
Lsp_51:
    ds_read_b32 v6, v3 offset:88
    s_add_u32 s66, s66, 1
    s_cmp_gt_u32 s66, 8000000
    s_waitcnt lgkmcnt(0)
    s_cbranch_scc1 Lsd_52
    v_readfirstlane_b32 s11, v6
    s_cmp_ge_u32 s11, 1
    s_cbranch_scc0 Lsp_51
Lsd_52:
    buffer_load_dwordx4 v[176:179], v4, s[40:43], s83 offen offset:0 sc1
    buffer_load_dwordx4 v[180:183], v4, s[40:43], s83 offen offset:1024 sc1
    buffer_load_dwordx4 v[184:187], v4, s[40:43], s83 offen offset:2048 sc1
    buffer_load_dwordx4 v[188:191], v4, s[40:43], s83 offen offset:3072 sc1
    buffer_load_dwordx4 v[192:195], v4, s[40:43], s84 offen offset:0 sc1
    buffer_load_dwordx4 v[196:199], v4, s[40:43], s84 offen offset:1024 sc1
    buffer_load_dwordx4 v[200:203], v4, s[40:43], s84 offen offset:2048 sc1
    buffer_load_dwordx4 v[204:207], v4, s[40:43], s84 offen offset:3072 sc1
    buffer_load_dwordx4 v[208:211], v4, s[40:43], s85 offen offset:0 sc1
    buffer_load_dwordx4 v[212:215], v4, s[40:43], s85 offen offset:1024 sc1
    buffer_load_dwordx4 v[216:219], v4, s[40:43], s85 offen offset:2048 sc1
    buffer_load_dwordx4 v[220:223], v4, s[40:43], s85 offen offset:3072 sc1
    buffer_load_dwordx4 v[224:227], v4, s[40:43], s86 offen offset:0 sc1
    buffer_load_dwordx4 v[228:231], v4, s[40:43], s86 offen offset:1024 sc1
    buffer_load_dwordx4 v[232:235], v4, s[40:43], s86 offen offset:2048 sc1
    buffer_load_dwordx4 v[236:239], v4, s[40:43], s86 offen offset:3072 sc1
    buffer_load_dwordx4 v[240:243], v4, s[40:43], s87 offen offset:0 sc1
    buffer_load_dwordx4 v[244:247], v4, s[40:43], s87 offen offset:1024 sc1
    buffer_load_dwordx4 v[248:251], v4, s[40:43], s87 offen offset:2048 sc1
    buffer_load_dwordx4 v[252:255], v4, s[40:43], s87 offen offset:3072 sc1
    s_branch Lwl_48
Lwl_47:
    s_mov_b32 s66, 0
Lsp_53:
    ds_read_b32 v6, v3 offset:88
    s_add_u32 s66, s66, 1
    s_cmp_gt_u32 s66, 8000000
    s_waitcnt lgkmcnt(0)
    s_cbranch_scc1 Lsd_54
    v_readfirstlane_b32 s11, v6
    s_cmp_ge_u32 s11, 1
    s_cbranch_scc0 Lsp_53
Lsd_54:
    buffer_load_dwordx4 v[128:131], v4, s[40:43], 0 offen offset:0 sc1
    buffer_load_dwordx4 v[132:135], v4, s[40:43], 0 offen offset:1024 sc1
    buffer_load_dwordx4 v[136:139], v4, s[40:43], 0 offen offset:2048 sc1
    buffer_load_dwordx4 v[140:143], v4, s[40:43], 0 offen offset:3072 sc1
    buffer_load_dwordx4 v[144:147], v4, s[40:43], s81 offen offset:0 sc1
    buffer_load_dwordx4 v[148:151], v4, s[40:43], s81 offen offset:1024 sc1
    buffer_load_dwordx4 v[152:155], v4, s[40:43], s81 offen offset:2048 sc1
    buffer_load_dwordx4 v[156:159], v4, s[40:43], s81 offen offset:3072 sc1
    buffer_load_dwordx4 v[160:163], v4, s[40:43], s82 offen offset:0 sc1
    buffer_load_dwordx4 v[164:167], v4, s[40:43], s82 offen offset:1024 sc1
    buffer_load_dwordx4 v[168:171], v4, s[40:43], s82 offen offset:2048 sc1
    buffer_load_dwordx4 v[172:175], v4, s[40:43], s82 offen offset:3072 sc1
    buffer_load_dwordx4 v[176:179], v4, s[40:43], s83 offen offset:0 sc1
    buffer_load_dwordx4 v[180:183], v4, s[40:43], s83 offen offset:1024 sc1
    buffer_load_dwordx4 v[184:187], v4, s[40:43], s83 offen offset:2048 sc1
    buffer_load_dwordx4 v[188:191], v4, s[40:43], s83 offen offset:3072 sc1
Lwl_48:
    s_lshl_b32 s60, s8, 3
    s_add_u32 s60, s60, s70
    s_mul_i32 s60, s60, 57344
    s_lshl_b32 s61, s3, 13
    s_add_u32 s60, s60, s61
    s_add_u32 s52, s4, 0xbdc000
    s_addc_u32 s53, s5, 0
    s_add_u32 s52, s52, s60
    s_addc_u32 s53, s53, 0
    s_mov_b32 s54, 0x62000
    s_mov_b32 s55, 0x20000
    v_and_b32 v6, 15, v1
    v_lshrrev_b32 v124, 4, v1
    v_xor_b32 v124, v124, v6
    v_lshlrev_b32 v124, 4, v124
    v_lshl_add_u32 v124, v6, 8, v124
    s_lshl_b32 s60, s3, 12
    v_add_u32 v124, s60, v124
    s_and_b32 s60, s3, 3
    s_lshl_b32 s60, s60, 2
    v_bfe_u32 v126, v1, 3, 2
    v_add_u32 v126, s60, v126
    v_and_b32 v125, 6, v1
    v_lshlrev_b32 v125, 1, v125
    v_and_b32 v6, 1, v1
    v_add_u32 v125, v125, v6
    v_lshrrev_b32 v7, 5, v1
    v_lshl_add_u32 v125, v7, 1, v125
    v_xor_b32 v125, v125, v126
    v_lshlrev_b32 v125, 4, v125
    v_lshl_add_u32 v125, v126, 8, v125
    v_and_b32 v6, 7, v1
    v_lshlrev_b32 v126, 10, v126
    v_lshl_add_u32 v126, v6, 4, v126
    v_lshl_add_u32 v126, v7, 3, v126
    v_lshlrev_b32 v127, 5, v6
    v_lshl_add_u32 v127, v7, 2, v127
    v_add_u32 v127, v127, v3
    s_lshl_b32 s88, s8, 17
    s_lshl_b32 s60, s70, 14
    s_add_u32 s88, s88, s60
    s_lshl_b32 s60, s71, 7
    s_add_u32 s88, s88, s60
    s_mul_i32 s60, s9, 16*1792
    s_lshl_b32 s61, s3, 9
    s_add_u32 s60, s60, s61
    s_add_u32 s44, s4, 0x9ac000
    s_addc_u32 s45, s5, 0
    s_add_u32 s44, s44, s60
    s_addc_u32 s45, s45, 0
    s_mov_b32 s46, 0x7000
    s_mov_b32 s47, 0x20000
    v_lshrrev_b32 v7, 5, v1
    v_bfe_u32 v6, v1, 2, 2
    v_lshl_add_u32 v12, v7, 3, v6
    v_lshlrev_b32 v12, 6, v12
    v_and_b32 v13, 16, v1
    v_lshl_add_u32 v12, v13, 1, v12
    v_and_b32 v13, 3, v1
    v_lshl_add_u32 v12, v13, 3, v12
    v_and_b32 v14, 31, v1
    v_lshl_add_u32 v14, v14, 4, v3
    v_mul_u32_u24 v10, 8*1792, v7
    v_and_b32 v9, 31, v1
    v_lshl_add_u32 v10, v9, 4, v10
    v_bfe_u32 v8, v1, 4, 1
    v_mul_u32_u24 v15, 57344, v8
    v_lshl_add_u32 v15, v7, 8, v15
    v_and_b32 v11, 15, v1
    v_lshl_add_u32 v15, v11, 4, v15
    s_mul_i32 s69, s8, 8*57344
    s_lshr_b32 s60, s68, 1
    s_lshl_b32 s60, s60, 10
    s_add_u32 s69, s69, s60
    s_and_b32 s60, s68, 1
    s_lshl_b32 s60, s60, 9
    s_add_u32 s69, s69, s60
    s_add_u32 s48, s4, 0xbdc000
    s_addc_u32 s49, s5, 0
    s_mov_b32 s50, 0x700000
    s_mov_b32 s51, 0x20000
    v_lshl_add_u32 v8, v8, 2, v6
    v_lshl_add_u32 v8, v8, 1, v7
    v_lshlrev_b32 v8, 6, v8
    v_lshl_add_u32 v8, v13, 3, v8
    s_lshl_b32 s60, s71, 12
    s_and_b32 s61, s3, 3
    s_lshl_b32 s62, s61, 10
    s_add_u32 s60, s60, s62
    s_lshl_b32 s62, s70, 5
    s_add_u32 s60, s60, s62
    v_add_u32 v8, s60, v8
    s_lshl_b32 s61, s61, 2
    v_lshrrev_b32 v9, 4, v1
    v_add_u32 v9, s61, v9
    v_xor_b32 v9, v9, v11
    v_lshlrev_b32 v9, 4, v9
    v_lshl_add_u32 v9, v11, 8, v9
    v_add_u32 v9, 0x20000, v9
    v_mov_b32 v11, v10
    s_lshl_b32 s72, s8, 11
    s_lshl_b32 s60, s9, 2
    s_add_u32 s72, s72, s60
    s_add_u32 s72, s72, 0x12e4000
    s_barrier
    ds_read_b64_tr_b16 v[64:65], v12 offset:0
    ds_read_b64_tr_b16 v[66:67], v12 offset:256
    ds_read_b64_tr_b16 v[68:69], v12 offset:32768
    ds_read_b64_tr_b16 v[70:71], v12 offset:33024
    ds_read_b64_tr_b16 v[72:73], v12 offset:1024
    ds_read_b64_tr_b16 v[74:75], v12 offset:1280
    ds_read_b64_tr_b16 v[76:77], v12 offset:33792
    ds_read_b64_tr_b16 v[78:79], v12 offset:34048
    s_setprio 2
    s_waitcnt vmcnt(15) lgkmcnt(6)
    v_mfma_f32_32x32x16_bf16 v[16:31], v[128:131], v[64:67], 0
    ds_read_b64_tr_b16 v[80:81], v12 offset:2048
    ds_read_b64_tr_b16 v[82:83], v12 offset:2304
    s_waitcnt lgkmcnt(6)
    v_mfma_f32_32x32x16_bf16 v[32:47], v[128:131], v[68:71], 0
    ds_read_b64_tr_b16 v[84:85], v12 offset:34816
    ds_read_b64_tr_b16 v[86:87], v12 offset:35072
    s_cmp_ge_u32 s3, 4
    s_cbranch_scc1 Lwl_55
    buffer_load_dwordx4 v[192:195], v4, s[40:43], s84 offen offset:0 sc1
Lwl_55:
    s_waitcnt vmcnt(14) lgkmcnt(6)
    v_mfma_f32_32x32x16_bf16 v[16:31], v[132:135], v[72:75], v[16:31]
    ds_read_b64_tr_b16 v[64:65], v12 offset:3072
    ds_read_b64_tr_b16 v[66:67], v12 offset:3328
    s_waitcnt lgkmcnt(6)
    v_mfma_f32_32x32x16_bf16 v[32:47], v[132:135], v[76:79], v[32:47]
    ds_read_b64_tr_b16 v[68:69], v12 offset:35840
    ds_read_b64_tr_b16 v[70:71], v12 offset:36096
    s_cmp_ge_u32 s3, 4
    s_cbranch_scc1 Lwl_56
    buffer_load_dwordx4 v[196:199], v4, s[40:43], s84 offen offset:1024 sc1
Lwl_56:
    s_waitcnt vmcnt(13) lgkmcnt(6)
    v_mfma_f32_32x32x16_bf16 v[16:31], v[136:139], v[80:83], v[16:31]
    ds_read_b64_tr_b16 v[72:73], v12 offset:4096
    ds_read_b64_tr_b16 v[74:75], v12 offset:4352
    s_waitcnt lgkmcnt(6)
    v_mfma_f32_32x32x16_bf16 v[32:47], v[136:139], v[84:87], v[32:47]
    ds_read_b64_tr_b16 v[76:77], v12 offset:36864
    ds_read_b64_tr_b16 v[78:79], v12 offset:37120
    s_cmp_ge_u32 s3, 4
    s_cbranch_scc1 Lwl_57
    buffer_load_dwordx4 v[200:203], v4, s[40:43], s84 offen offset:2048 sc1
Lwl_57:
    s_waitcnt vmcnt(12) lgkmcnt(6)
    v_mfma_f32_32x32x16_bf16 v[16:31], v[140:143], v[64:67], v[16:31]
    ds_read_b64_tr_b16 v[80:81], v12 offset:5120
    ds_read_b64_tr_b16 v[82:83], v12 offset:5376
    s_waitcnt lgkmcnt(6)
    v_mfma_f32_32x32x16_bf16 v[32:47], v[140:143], v[68:71], v[32:47]
    ds_read_b64_tr_b16 v[84:85], v12 offset:37888
    ds_read_b64_tr_b16 v[86:87], v12 offset:38144
    s_cmp_ge_u32 s3, 4
    s_cbranch_scc1 Lwl_58
    buffer_load_dwordx4 v[204:207], v4, s[40:43], s84 offen offset:3072 sc1
Lwl_58:
    s_setprio 1
    s_waitcnt vmcnt(11) lgkmcnt(6)
    v_mfma_f32_32x32x16_bf16 v[16:31], v[144:147], v[72:75], v[16:31]
    ds_read_b64_tr_b16 v[64:65], v12 offset:6144
    ds_read_b64_tr_b16 v[66:67], v12 offset:6400
    s_waitcnt lgkmcnt(6)
    v_mfma_f32_32x32x16_bf16 v[32:47], v[144:147], v[76:79], v[32:47]
    ds_read_b64_tr_b16 v[68:69], v12 offset:38912
    ds_read_b64_tr_b16 v[70:71], v12 offset:39168
    ds_read_b32 v10, v3 offset:108
    s_cmp_ge_u32 s3, 4
    s_cbranch_scc1 Lwl_59
    buffer_load_dwordx4 v[208:211], v4, s[40:43], s85 offen offset:0 sc1
Lwl_59:
    s_waitcnt vmcnt(10) lgkmcnt(7)
    v_mfma_f32_32x32x16_bf16 v[16:31], v[148:151], v[80:83], v[16:31]
    ds_read_b64_tr_b16 v[72:73], v12 offset:7168
    ds_read_b64_tr_b16 v[74:75], v12 offset:7424
    s_waitcnt lgkmcnt(7)
    v_mfma_f32_32x32x16_bf16 v[32:47], v[148:151], v[84:87], v[32:47]
    ds_read_b64_tr_b16 v[76:77], v12 offset:39936
    ds_read_b64_tr_b16 v[78:79], v12 offset:40192
    s_cmp_ge_u32 s3, 4
    s_cbranch_scc1 Lwl_60
    buffer_load_dwordx4 v[212:215], v4, s[40:43], s85 offen offset:1024 sc1
Lwl_60:
    s_waitcnt lgkmcnt(4)
    v_readfirstlane_b32 s11, v10
    s_cmp_ge_u32 s11, 1
    s_cbranch_scc1 Lxl_61
    s_mov_b32 s66, 0
Lsp_62:
    ds_read_b32 v6, v3 offset:108
    s_add_u32 s66, s66, 1
    s_cmp_gt_u32 s66, 8000000
    s_waitcnt lgkmcnt(0)
    s_cbranch_scc1 Lsd_63
    v_readfirstlane_b32 s11, v6
    s_cmp_ge_u32 s11, 1
    s_cbranch_scc0 Lsp_62
Lsd_63:
Lxl_61:
    s_waitcnt vmcnt(9)
    v_mfma_f32_32x32x16_bf16 v[16:31], v[152:155], v[64:67], v[16:31]
    ds_read_b64_tr_b16 v[80:81], v12 offset:8192
    ds_read_b64_tr_b16 v[82:83], v12 offset:8448
    v_mfma_f32_32x32x16_bf16 v[32:47], v[152:155], v[68:71], v[32:47]
    ds_read_b64_tr_b16 v[84:85], v12 offset:40960
    ds_read_b64_tr_b16 v[86:87], v12 offset:41216
    s_cmp_ge_u32 s3, 4
    s_cbranch_scc1 Lwl_64
    buffer_load_dwordx4 v[216:219], v4, s[40:43], s85 offen offset:2048 sc1
Lwl_64:
    s_waitcnt vmcnt(8) lgkmcnt(6)
    v_mfma_f32_32x32x16_bf16 v[16:31], v[156:159], v[72:75], v[16:31]
    ds_read_b64_tr_b16 v[64:65], v12 offset:9216
    ds_read_b64_tr_b16 v[66:67], v12 offset:9472
    s_waitcnt lgkmcnt(6)
    v_mfma_f32_32x32x16_bf16 v[32:47], v[156:159], v[76:79], v[32:47]
    ds_read_b64_tr_b16 v[68:69], v12 offset:41984
    ds_read_b64_tr_b16 v[70:71], v12 offset:42240
    s_cmp_ge_u32 s3, 4
    s_cbranch_scc1 Lwl_65
    buffer_load_dwordx4 v[220:223], v4, s[40:43], s85 offen offset:3072 sc1
Lwl_65:
    s_setprio 0
    s_waitcnt vmcnt(7) lgkmcnt(6)
    v_mfma_f32_32x32x16_bf16 v[16:31], v[160:163], v[80:83], v[16:31]
    ds_read_b64_tr_b16 v[72:73], v12 offset:10240
    ds_read_b64_tr_b16 v[74:75], v12 offset:10496
    s_waitcnt lgkmcnt(6)
    v_mfma_f32_32x32x16_bf16 v[32:47], v[160:163], v[84:87], v[32:47]
    ds_read_b64_tr_b16 v[76:77], v12 offset:43008
    ds_read_b64_tr_b16 v[78:79], v12 offset:43264
    s_cmp_ge_u32 s3, 4
    s_cbranch_scc1 Lwl_66
    buffer_load_dwordx4 v[224:227], v4, s[40:43], s86 offen offset:0 sc1
Lwl_66:
    s_waitcnt vmcnt(6) lgkmcnt(6)
    v_mfma_f32_32x32x16_bf16 v[16:31], v[164:167], v[64:67], v[16:31]
    ds_read_b64_tr_b16 v[80:81], v12 offset:11264
    ds_read_b64_tr_b16 v[82:83], v12 offset:11520
    s_waitcnt lgkmcnt(6)
    v_mfma_f32_32x32x16_bf16 v[32:47], v[164:167], v[68:71], v[32:47]
    ds_read_b64_tr_b16 v[84:85], v12 offset:44032
    ds_read_b64_tr_b16 v[86:87], v12 offset:44288
    s_cmp_ge_u32 s3, 4
    s_cbranch_scc1 Lwl_67
    buffer_load_dwordx4 v[228:231], v4, s[40:43], s86 offen offset:1024 sc1
Lwl_67:
    s_waitcnt vmcnt(5) lgkmcnt(6)
    v_mfma_f32_32x32x16_bf16 v[16:31], v[168:171], v[72:75], v[16:31]
    ds_read_b64_tr_b16 v[64:65], v12 offset:12288
    ds_read_b64_tr_b16 v[66:67], v12 offset:12544
    s_waitcnt lgkmcnt(6)
    v_mfma_f32_32x32x16_bf16 v[32:47], v[168:171], v[76:79], v[32:47]
    ds_read_b64_tr_b16 v[68:69], v12 offset:45056
    ds_read_b64_tr_b16 v[70:71], v12 offset:45312
    s_cmp_ge_u32 s3, 4
    s_cbranch_scc1 Lwl_68
    buffer_load_dwordx4 v[232:235], v4, s[40:43], s86 offen offset:2048 sc1
Lwl_68:
    s_waitcnt vmcnt(4) lgkmcnt(6)
    v_mfma_f32_32x32x16_bf16 v[16:31], v[172:175], v[80:83], v[16:31]
    ds_read_b64_tr_b16 v[72:73], v12 offset:13312
    ds_read_b64_tr_b16 v[74:75], v12 offset:13568
    s_waitcnt lgkmcnt(6)
    v_mfma_f32_32x32x16_bf16 v[32:47], v[172:175], v[84:87], v[32:47]
    ds_read_b64_tr_b16 v[76:77], v12 offset:46080
    ds_read_b64_tr_b16 v[78:79], v12 offset:46336
    s_cmp_ge_u32 s3, 4
    s_cbranch_scc1 Lwl_69
    buffer_load_dwordx4 v[236:239], v4, s[40:43], s86 offen offset:3072 sc1
Lwl_69:
    s_setprio 2
    s_waitcnt vmcnt(3) lgkmcnt(6)
    v_mfma_f32_32x32x16_bf16 v[16:31], v[176:179], v[64:67], v[16:31]
    ds_read_b64_tr_b16 v[80:81], v12 offset:14336
    ds_read_b64_tr_b16 v[82:83], v12 offset:14592
    s_waitcnt lgkmcnt(6)
    v_mfma_f32_32x32x16_bf16 v[32:47], v[176:179], v[68:71], v[32:47]
    ds_read_b64_tr_b16 v[84:85], v12 offset:47104
    ds_read_b64_tr_b16 v[86:87], v12 offset:47360
    ds_read_b32 v10, v3 offset:108
    s_cmp_ge_u32 s3, 4
    s_cbranch_scc1 Lwl_70
    buffer_load_dwordx4 v[240:243], v4, s[40:43], s87 offen offset:0 sc1
Lwl_70:
    s_waitcnt vmcnt(2) lgkmcnt(7)
    v_mfma_f32_32x32x16_bf16 v[16:31], v[180:183], v[72:75], v[16:31]
    ds_read_b64_tr_b16 v[64:65], v12 offset:15360
    ds_read_b64_tr_b16 v[66:67], v12 offset:15616
    s_waitcnt lgkmcnt(7)
    v_mfma_f32_32x32x16_bf16 v[32:47], v[180:183], v[76:79], v[32:47]
    ds_read_b64_tr_b16 v[68:69], v12 offset:48128
    ds_read_b64_tr_b16 v[70:71], v12 offset:48384
    s_cmp_ge_u32 s3, 4
    s_cbranch_scc1 Lwl_71
    buffer_load_dwordx4 v[244:247], v4, s[40:43], s87 offen offset:1024 sc1
Lwl_71:
    s_waitcnt lgkmcnt(4)
    v_readfirstlane_b32 s11, v10
    s_cmp_ge_u32 s11, 2
    s_cbranch_scc1 Lxl_72
    s_mov_b32 s66, 0
Lsp_73:
    ds_read_b32 v6, v3 offset:108
    s_add_u32 s66, s66, 1
    s_cmp_gt_u32 s66, 8000000
    s_waitcnt lgkmcnt(0)
    s_cbranch_scc1 Lsd_74
    v_readfirstlane_b32 s11, v6
    s_cmp_ge_u32 s11, 2
    s_cbranch_scc0 Lsp_73
Lsd_74:
Lxl_72:
    s_waitcnt vmcnt(1)
    v_mfma_f32_32x32x16_bf16 v[16:31], v[184:187], v[80:83], v[16:31]
    ds_read_b64_tr_b16 v[72:73], v12 offset:16384
    ds_read_b64_tr_b16 v[74:75], v12 offset:16640
    v_mfma_f32_32x32x16_bf16 v[32:47], v[184:187], v[84:87], v[32:47]
    ds_read_b64_tr_b16 v[76:77], v12 offset:49152
    ds_read_b64_tr_b16 v[78:79], v12 offset:49408
    s_cmp_ge_u32 s3, 4
    s_cbranch_scc1 Lwl_75
    buffer_load_dwordx4 v[248:251], v4, s[40:43], s87 offen offset:2048 sc1
Lwl_75:
    s_waitcnt vmcnt(0) lgkmcnt(6)
    v_mfma_f32_32x32x16_bf16 v[16:31], v[188:191], v[64:67], v[16:31]
    ds_read_b64_tr_b16 v[80:81], v12 offset:17408
    ds_read_b64_tr_b16 v[82:83], v12 offset:17664
    s_waitcnt lgkmcnt(6)
    v_mfma_f32_32x32x16_bf16 v[32:47], v[188:191], v[68:71], v[32:47]
    ds_read_b64_tr_b16 v[84:85], v12 offset:50176
    ds_read_b64_tr_b16 v[86:87], v12 offset:50432
    s_cmp_ge_u32 s3, 4
    s_cbranch_scc1 Lwl_76
    buffer_load_dwordx4 v[252:255], v4, s[40:43], s87 offen offset:3072 sc1
Lwl_76:
    s_setprio 1
    s_waitcnt vmcnt(15) lgkmcnt(6)
    v_mfma_f32_32x32x16_bf16 v[16:31], v[192:195], v[72:75], v[16:31]
    ds_read_b64_tr_b16 v[64:65], v12 offset:18432
    ds_read_b64_tr_b16 v[66:67], v12 offset:18688
    s_waitcnt lgkmcnt(6)
    v_mfma_f32_32x32x16_bf16 v[32:47], v[192:195], v[76:79], v[32:47]
    ds_read_b64_tr_b16 v[68:69], v12 offset:51200
    ds_read_b64_tr_b16 v[70:71], v12 offset:51456
    buffer_load_dwordx4 v[100:103], v11, s[44:47], 0 offen offset:0 sc1
    s_waitcnt vmcnt(15) lgkmcnt(6)
    v_mfma_f32_32x32x16_bf16 v[16:31], v[196:199], v[80:83], v[16:31]
    ds_read_b64_tr_b16 v[72:73], v12 offset:19456
    ds_read_b64_tr_b16 v[74:75], v12 offset:19712
    s_waitcnt lgkmcnt(6)
    v_mfma_f32_32x32x16_bf16 v[32:47], v[196:199], v[84:87], v[32:47]
    ds_read_b64_tr_b16 v[76:77], v12 offset:52224
    ds_read_b64_tr_b16 v[78:79], v12 offset:52480
    buffer_load_dwordx4 v[104:107], v11, s[44:47], 0 offen offset:3584 sc1
    v_add_u32 v11, 7168, v11
    s_waitcnt vmcnt(15) lgkmcnt(6)
    v_mfma_f32_32x32x16_bf16 v[16:31], v[200:203], v[64:67], v[16:31]
    ds_read_b64_tr_b16 v[80:81], v12 offset:20480
    ds_read_b64_tr_b16 v[82:83], v12 offset:20736
    s_waitcnt lgkmcnt(6)
    v_mfma_f32_32x32x16_bf16 v[32:47], v[200:203], v[68:71], v[32:47]
    ds_read_b64_tr_b16 v[84:85], v12 offset:53248
    ds_read_b64_tr_b16 v[86:87], v12 offset:53504
    buffer_load_dwordx4 v[108:111], v11, s[44:47], 0 offen offset:0 sc1
    ds_read_b64_tr_b16 v[96:97], v8 offset:0
    s_waitcnt vmcnt(15) lgkmcnt(7)
    v_mfma_f32_32x32x16_bf16 v[16:31], v[204:207], v[72:75], v[16:31]
    ds_read_b64_tr_b16 v[64:65], v12 offset:21504
    ds_read_b64_tr_b16 v[66:67], v12 offset:21760
    s_waitcnt lgkmcnt(7)
    v_mfma_f32_32x32x16_bf16 v[32:47], v[204:207], v[76:79], v[32:47]
    ds_read_b64_tr_b16 v[68:69], v12 offset:54272
    ds_read_b64_tr_b16 v[70:71], v12 offset:54528
    buffer_load_dwordx4 v[112:115], v11, s[44:47], 0 offen offset:3584 sc1
    s_setprio 0
    s_waitcnt vmcnt(15) lgkmcnt(7)
    v_mfma_f32_32x32x16_bf16 v[16:31], v[208:211], v[80:83], v[16:31]
    ds_read_b64_tr_b16 v[72:73], v12 offset:22528
    ds_read_b64_tr_b16 v[74:75], v12 offset:22784
    s_waitcnt lgkmcnt(7)
    v_mfma_f32_32x32x16_bf16 v[32:47], v[208:211], v[84:87], v[32:47]
    ds_read_b64_tr_b16 v[76:77], v12 offset:55296
    ds_read_b64_tr_b16 v[78:79], v12 offset:55552
    s_waitcnt lgkmcnt(8)
    v_lshlrev_b32 v92, 16, v96
    v_and_b32 v93, s10, v96
    v_lshlrev_b32 v94, 16, v97
    v_and_b32 v95, s10, v97
    ds_write_b128 v9, v[92:95] offset:0
    s_waitcnt vmcnt(14) lgkmcnt(7)
    v_mfma_f32_32x32x16_bf16 v[16:31], v[212:215], v[64:67], v[16:31]
    ds_read_b64_tr_b16 v[80:81], v12 offset:23552
    ds_read_b64_tr_b16 v[82:83], v12 offset:23808
    s_waitcnt lgkmcnt(7)
    v_mfma_f32_32x32x16_bf16 v[32:47], v[212:215], v[68:71], v[32:47]
    ds_read_b64_tr_b16 v[84:85], v12 offset:56320
    ds_read_b64_tr_b16 v[86:87], v12 offset:56576
    s_waitcnt vmcnt(13) lgkmcnt(7)
    v_mfma_f32_32x32x16_bf16 v[16:31], v[216:219], v[72:75], v[16:31]
    ds_read_b64_tr_b16 v[64:65], v12 offset:24576
    ds_read_b64_tr_b16 v[66:67], v12 offset:24832
    s_waitcnt lgkmcnt(7)
    v_mfma_f32_32x32x16_bf16 v[32:47], v[216:219], v[76:79], v[32:47]
    ds_read_b64_tr_b16 v[68:69], v12 offset:57344
    ds_read_b64_tr_b16 v[70:71], v12 offset:57600
    ds_read_b64_tr_b16 v[96:97], v8 offset:32768
    s_waitcnt vmcnt(12) lgkmcnt(7)
    v_mfma_f32_32x32x16_bf16 v[16:31], v[220:223], v[80:83], v[16:31]
    ds_read_b64_tr_b16 v[72:73], v12 offset:25600
    ds_read_b64_tr_b16 v[74:75], v12 offset:25856
    s_waitcnt lgkmcnt(7)
    v_mfma_f32_32x32x16_bf16 v[32:47], v[220:223], v[84:87], v[32:47]
    ds_read_b64_tr_b16 v[76:77], v12 offset:58368
    ds_read_b64_tr_b16 v[78:79], v12 offset:58624
    s_setprio 2
    s_waitcnt vmcnt(11) lgkmcnt(7)
    v_mfma_f32_32x32x16_bf16 v[16:31], v[224:227], v[64:67], v[16:31]
    ds_read_b64_tr_b16 v[80:81], v12 offset:26624
    ds_read_b64_tr_b16 v[82:83], v12 offset:26880
    s_waitcnt lgkmcnt(7)
    v_mfma_f32_32x32x16_bf16 v[32:47], v[224:227], v[68:71], v[32:47]
    ds_read_b64_tr_b16 v[84:85], v12 offset:59392
    ds_read_b64_tr_b16 v[86:87], v12 offset:59648
    s_waitcnt lgkmcnt(8)
    v_lshlrev_b32 v92, 16, v96
    v_and_b32 v93, s10, v96
    v_lshlrev_b32 v94, 16, v97
    v_and_b32 v95, s10, v97
    ds_write_b128 v9, v[92:95] offset:4096
    s_waitcnt vmcnt(10) lgkmcnt(7)
    v_mfma_f32_32x32x16_bf16 v[16:31], v[228:231], v[72:75], v[16:31]
    ds_read_b64_tr_b16 v[64:65], v12 offset:27648
    ds_read_b64_tr_b16 v[66:67], v12 offset:27904
    s_waitcnt lgkmcnt(7)
    v_mfma_f32_32x32x16_bf16 v[32:47], v[228:231], v[76:79], v[32:47]
    ds_read_b64_tr_b16 v[68:69], v12 offset:60416
    ds_read_b64_tr_b16 v[70:71], v12 offset:60672
    s_waitcnt vmcnt(1)
    v_add_f32 v100, v100, v108
    v_add_f32 v101, v101, v109
    v_add_f32 v102, v102, v110
    v_add_f32 v103, v103, v111
    s_waitcnt vmcnt(0)
    v_add_f32 v104, v104, v112
    v_add_f32 v105, v105, v113
    v_add_f32 v106, v106, v114
    v_add_f32 v107, v107, v115
    s_waitcnt lgkmcnt(7)
    v_mfma_f32_32x32x16_bf16 v[16:31], v[232:235], v[80:83], v[16:31]
    ds_read_b64_tr_b16 v[72:73], v12 offset:28672
    ds_read_b64_tr_b16 v[74:75], v12 offset:28928
    s_waitcnt lgkmcnt(7)
    v_mfma_f32_32x32x16_bf16 v[32:47], v[232:235], v[84:87], v[32:47]
    ds_read_b64_tr_b16 v[76:77], v12 offset:61440
    ds_read_b64_tr_b16 v[78:79], v12 offset:61696
    v_add_f32 v100, v100, v104
    v_add_f32 v101, v101, v105
    v_add_f32 v102, v102, v106
    v_add_f32 v103, v103, v107
    v_add_f32 v100, v100, v102
    v_add_f32 v101, v101, v103
    s_waitcnt lgkmcnt(6)
    v_mfma_f32_32x32x16_bf16 v[16:31], v[236:239], v[64:67], v[16:31]
    ds_read_b64_tr_b16 v[80:81], v12 offset:29696
    ds_read_b64_tr_b16 v[82:83], v12 offset:29952
    s_waitcnt lgkmcnt(6)
    v_mfma_f32_32x32x16_bf16 v[32:47], v[236:239], v[68:71], v[32:47]
    ds_read_b64_tr_b16 v[84:85], v12 offset:62464
    ds_read_b64_tr_b16 v[86:87], v12 offset:62720
    v_cvt_pk_bf16_f32 v102, v100, v101
    v_lshlrev_b32 v104, 16, v102
    v_and_b32 v105, s10, v102
    v_sub_f32 v100, v100, v104
    v_sub_f32 v101, v101, v105
    v_cvt_pk_bf16_f32 v103, v100, v101
    s_mov_b32 s60, 0x01000100
    s_mov_b32 s61, 0x07060100
    s_mov_b32 s62, 0x07060302
    v_perm_b32 v88, v102, v102, s60
    v_perm_b32 v89, v102, v103, s61
    v_perm_b32 v90, v103, v102, s62
    v_mov_b32 v91, 0
    s_setprio 1
    s_waitcnt lgkmcnt(6)
    v_mfma_f32_32x32x16_bf16 v[16:31], v[240:243], v[72:75], v[16:31]
    ds_read_b64_tr_b16 v[64:65], v12 offset:30720
    ds_read_b64_tr_b16 v[66:67], v12 offset:30976
    s_waitcnt lgkmcnt(6)
    v_mfma_f32_32x32x16_bf16 v[32:47], v[240:243], v[76:79], v[32:47]
    ds_read_b64_tr_b16 v[68:69], v12 offset:63488
    ds_read_b64_tr_b16 v[70:71], v12 offset:63744
    ds_read_b32 v10, v3 offset:108
    s_waitcnt lgkmcnt(7)
    v_mfma_f32_32x32x16_bf16 v[16:31], v[244:247], v[80:83], v[16:31]
    ds_read_b64_tr_b16 v[72:73], v12 offset:31744
    ds_read_b64_tr_b16 v[74:75], v12 offset:32000
    s_waitcnt lgkmcnt(7)
    v_mfma_f32_32x32x16_bf16 v[32:47], v[244:247], v[84:87], v[32:47]
    ds_read_b64_tr_b16 v[76:77], v12 offset:64512
    ds_read_b64_tr_b16 v[78:79], v12 offset:64768
    s_waitcnt lgkmcnt(7)
    v_mfma_f32_32x32x16_bf16 v[16:31], v[248:251], v[64:67], v[16:31]
    s_waitcnt lgkmcnt(4)
    v_readfirstlane_b32 s11, v10
    s_cmp_ge_u32 s11, 3
    s_cbranch_scc1 Lxl_77
    s_mov_b32 s66, 0
Lsp_78:
    ds_read_b32 v6, v3 offset:108
    s_add_u32 s66, s66, 1
    s_cmp_gt_u32 s66, 8000000
    s_waitcnt lgkmcnt(0)
    s_cbranch_scc1 Lsd_79
    v_readfirstlane_b32 s11, v6
    s_cmp_ge_u32 s11, 3
    s_cbranch_scc0 Lsp_78
Lsd_79:
Lxl_77:
    v_add_u32 v12, 0x10000, v12
    ds_read_b64_tr_b16 v[80:81], v12 offset:0
    ds_read_b64_tr_b16 v[82:83], v12 offset:256
    v_mfma_f32_32x32x16_bf16 v[32:47], v[248:251], v[68:71], v[32:47]
    ds_read_b64_tr_b16 v[84:85], v12 offset:1024
    ds_read_b64_tr_b16 v[86:87], v12 offset:1280
    s_waitcnt lgkmcnt(6)
    v_mfma_f32_32x32x16_bf16 v[16:31], v[252:255], v[72:75], v[16:31]
    ds_read_b64_tr_b16 v[64:65], v12 offset:2048
    ds_read_b64_tr_b16 v[66:67], v12 offset:2304
    s_waitcnt lgkmcnt(6)
    v_mfma_f32_32x32x16_bf16 v[32:47], v[252:255], v[76:79], v[32:47]
    ds_read_b64_tr_b16 v[68:69], v12 offset:3072
    ds_read_b64_tr_b16 v[70:71], v12 offset:3328
    s_mov_b64 exec, 1
    ds_add_rtn_u32 v6, v3, v5 offset:120
    s_mov_b64 exec, -1
    s_mul_i32 s60, s3, 9216
    v_add_u32 v11, s60, v4
    s_setprio 0
    s_waitcnt lgkmcnt(7)
    v_mfma_f32_32x32x16_bf16 v[48:63], v[128:131], v[80:83], 0
    ds_read_b64_tr_b16 v[72:73], v12 offset:4096
    ds_read_b64_tr_b16 v[74:75], v12 offset:4352
    ds_read_b32 v10, v3 offset:48
    ds_read_b128 v[92:95], v14 offset:512
    ds_read_b128 v[96:99], v14 offset:2560
    s_waitcnt lgkmcnt(10)
    v_mfma_f32_32x32x16_bf16 v[48:63], v[132:135], v[84:87], v[48:63]
    ds_read_b64_tr_b16 v[76:77], v12 offset:5120
    ds_read_b64_tr_b16 v[78:79], v12 offset:5376
    s_waitcnt lgkmcnt(4)
    v_readfirstlane_b32 s11, v10
    s_cmp_ge_u32 s11, 1
    s_cbranch_scc1 Lf_81
    s_mov_b32 s66, 0
Lsp_82:
    ds_read_b32 v6, v3 offset:48
    s_add_u32 s66, s66, 1
    s_cmp_gt_u32 s66, 8000000
    s_waitcnt lgkmcnt(0)
    s_cbranch_scc1 Lsd_83
    v_readfirstlane_b32 s11, v6
    s_cmp_ge_u32 s11, 1
    s_cbranch_scc0 Lsp_82
Lsd_83:
    ds_read_b128 v[92:95], v14 offset:512
    ds_read_b128 v[96:99], v14 offset:2560
    s_waitcnt lgkmcnt(0)
Lf_81:
    s_waitcnt lgkmcnt(3)
    v_mfma_f32_32x32x16_bf16 v[16:31], v[88:91], v[92:95], v[16:31]
    buffer_load_dwordx4 v[100:103], v4, s[56:59], 0 offen offset:0 sc1
    v_mfma_f32_32x32x16_bf16 v[48:63], v[136:139], v[64:67], v[48:63]
    ds_read_b64_tr_b16 v[80:81], v12 offset:6144
    ds_read_b64_tr_b16 v[82:83], v12 offset:6400
    s_nop 7
    v_mul_f32 v92, v16, v16
    v_mul_f32 v93, v17, v17
    v_mul_f32 v94, v18, v18
    v_mul_f32 v95, v19, v19
    s_waitcnt lgkmcnt(4)
    v_fma_f32 v92, v92, v97, v96
    v_mfma_f32_32x32x16_bf16 v[48:63], v[140:143], v[68:71], v[48:63]
    ds_read_b64_tr_b16 v[84:85], v12 offset:7168
    ds_read_b64_tr_b16 v[86:87], v12 offset:7424
    v_fma_f32 v93, v93, v97, v96
    v_fma_f32 v94, v94, v97, v96
    v_fma_f32 v95, v95, v97, v96
    v_mul_f32 v92, v92, v16
    v_mul_f32 v93, v93, v17
    s_setprio 2
    v_mfma_f32_32x32x16_bf16 v[48:63], v[144:147], v[72:75], v[48:63]
    ds_read_b64_tr_b16 v[64:65], v12 offset:8192
    ds_read_b64_tr_b16 v[66:67], v12 offset:8448
    v_mul_f32 v94, v94, v18
    v_mul_f32 v95, v95, v19
    v_exp_f32 v92, v92
    v_mul_f32 v24, v24, v16
    v_exp_f32 v93, v93
    s_waitcnt lgkmcnt(6)
    v_mfma_f32_32x32x16_bf16 v[48:63], v[148:151], v[76:79], v[48:63]
    ds_read_b64_tr_b16 v[68:69], v12 offset:9216
    ds_read_b64_tr_b16 v[70:71], v12 offset:9472
    v_mul_f32 v25, v25, v17
    v_exp_f32 v94, v94
    v_mul_f32 v26, v26, v18
    v_exp_f32 v95, v95
    v_mul_f32 v27, v27, v19
    buffer_load_dwordx4 v[104:107], v4, s[56:59], 0 offen offset:1024 sc1
    s_waitcnt lgkmcnt(6)
    v_mfma_f32_32x32x16_bf16 v[48:63], v[152:155], v[80:83], v[48:63]
    ds_read_b64_tr_b16 v[72:73], v12 offset:10240
    ds_read_b64_tr_b16 v[74:75], v12 offset:10496
    v_fma_f32 v92, v92, v98, v98
    v_fma_f32 v93, v93, v98, v98
    v_fma_f32 v94, v94, v98, v98
    v_fma_f32 v95, v95, v98, v98
    v_rcp_f32 v92, v92
    s_waitcnt lgkmcnt(6)
    v_mfma_f32_32x32x16_bf16 v[48:63], v[156:159], v[84:87], v[48:63]
    ds_read_b64_tr_b16 v[76:77], v12 offset:11264
    ds_read_b64_tr_b16 v[78:79], v12 offset:11520
    v_rcp_f32 v93, v93
    v_rcp_f32 v94, v94
    v_rcp_f32 v95, v95
    v_mul_f32 v24, v24, v92
    v_mul_f32 v25, v25, v93
    s_setprio 1
    s_waitcnt lgkmcnt(6)
    v_mfma_f32_32x32x16_bf16 v[48:63], v[160:163], v[64:67], v[48:63]
    ds_read_b64_tr_b16 v[80:81], v12 offset:12288
    ds_read_b64_tr_b16 v[82:83], v12 offset:12544
    v_mul_f32 v26, v26, v94
    v_mul_f32 v27, v27, v95
    v_mul_f32 v92, v20, v20
    v_mul_f32 v93, v21, v21
    v_mul_f32 v94, v22, v22
    s_waitcnt lgkmcnt(6)
    v_mfma_f32_32x32x16_bf16 v[48:63], v[164:167], v[68:71], v[48:63]
    ds_read_b64_tr_b16 v[84:85], v12 offset:13312
    ds_read_b64_tr_b16 v[86:87], v12 offset:13568
    v_mul_f32 v95, v23, v23
    v_fma_f32 v92, v92, v97, v96
    v_fma_f32 v93, v93, v97, v96
    v_fma_f32 v94, v94, v97, v96
    v_fma_f32 v95, v95, v97, v96
    buffer_load_dwordx4 v[108:111], v4, s[56:59], 0 offen offset:2048 sc1
    s_waitcnt lgkmcnt(6)
    v_mfma_f32_32x32x16_bf16 v[48:63], v[168:171], v[72:75], v[48:63]
    ds_read_b64_tr_b16 v[64:65], v12 offset:14336
    ds_read_b64_tr_b16 v[66:67], v12 offset:14592
    v_mul_f32 v92, v92, v20
    v_mul_f32 v93, v93, v21
    v_mul_f32 v94, v94, v22
    v_mul_f32 v95, v95, v23
    v_exp_f32 v92, v92
    s_waitcnt lgkmcnt(6)
    v_mfma_f32_32x32x16_bf16 v[48:63], v[172:175], v[76:79], v[48:63]
    ds_read_b64_tr_b16 v[68:69], v12 offset:15360
    ds_read_b64_tr_b16 v[70:71], v12 offset:15616
    v_mul_f32 v28, v28, v20
    v_exp_f32 v93, v93
    v_mul_f32 v29, v29, v21
    v_exp_f32 v94, v94
    v_mul_f32 v30, v30, v22
    s_setprio 0
    s_waitcnt lgkmcnt(6)
    v_mfma_f32_32x32x16_bf16 v[48:63], v[176:179], v[80:83], v[48:63]
    ds_read_b64_tr_b16 v[72:73], v12 offset:16384
    ds_read_b64_tr_b16 v[74:75], v12 offset:16640
    v_exp_f32 v95, v95
    v_mul_f32 v31, v31, v23
    v_fma_f32 v92, v92, v98, v98
    v_fma_f32 v93, v93, v98, v98
    v_fma_f32 v94, v94, v98, v98
    s_waitcnt lgkmcnt(6)
    v_mfma_f32_32x32x16_bf16 v[48:63], v[180:183], v[84:87], v[48:63]
    ds_read_b64_tr_b16 v[76:77], v12 offset:17408
    ds_read_b64_tr_b16 v[78:79], v12 offset:17664
    v_fma_f32 v95, v95, v98, v98
    v_rcp_f32 v92, v92
    v_rcp_f32 v93, v93
    v_rcp_f32 v94, v94
    v_rcp_f32 v95, v95
    buffer_load_dwordx4 v[112:115], v4, s[56:59], 0 offen offset:3072 sc1
    s_waitcnt lgkmcnt(6)
    v_mfma_f32_32x32x16_bf16 v[48:63], v[184:187], v[64:67], v[48:63]
    ds_read_b64_tr_b16 v[80:81], v12 offset:18432
    ds_read_b64_tr_b16 v[82:83], v12 offset:18688
    v_mul_f32 v28, v28, v92
    v_mul_f32 v29, v29, v93
    v_mul_f32 v30, v30, v94
    v_mul_f32 v31, v31, v95
    v_cvt_pk_bf16_f32 v16, v24, v28
    s_waitcnt lgkmcnt(6)
    v_mfma_f32_32x32x16_bf16 v[48:63], v[188:191], v[68:71], v[48:63]
    ds_read_b64_tr_b16 v[84:85], v12 offset:19456
    ds_read_b64_tr_b16 v[86:87], v12 offset:19712
    v_cvt_pk_bf16_f32 v17, v25, v29
    v_cvt_pk_bf16_f32 v18, v26, v30
    v_cvt_pk_bf16_f32 v19, v27, v31
    buffer_store_dwordx4 v[16:19], v15, s[48:51], s69 offen sc1
    s_add_u32 s69, s69, 114688
    s_setprio 2
    s_waitcnt lgkmcnt(6)
    v_mfma_f32_32x32x16_bf16 v[48:63], v[192:195], v[72:75], v[48:63]
    ds_read_b64_tr_b16 v[64:65], v12 offset:20480
    ds_read_b64_tr_b16 v[66:67], v12 offset:20736
    ds_read_b32 v10, v3 offset:48
    ds_read_b128 v[92:95], v14 offset:1024
    ds_read_b128 v[96:99], v14 offset:3072
    s_waitcnt lgkmcnt(9)
    v_mfma_f32_32x32x16_bf16 v[48:63], v[196:199], v[76:79], v[48:63]
    ds_read_b64_tr_b16 v[68:69], v12 offset:21504
    ds_read_b64_tr_b16 v[70:71], v12 offset:21760
    s_waitcnt lgkmcnt(4)
    v_readfirstlane_b32 s11, v10
    s_cmp_ge_u32 s11, 2
    s_cbranch_scc1 Lf_84
    s_mov_b32 s66, 0
Lsp_85:
    ds_read_b32 v6, v3 offset:48
    s_add_u32 s66, s66, 1
    s_cmp_gt_u32 s66, 8000000
    s_waitcnt lgkmcnt(0)
    s_cbranch_scc1 Lsd_86
    v_readfirstlane_b32 s11, v6
    s_cmp_ge_u32 s11, 2
    s_cbranch_scc0 Lsp_85
Lsd_86:
    ds_read_b128 v[92:95], v14 offset:1024
    ds_read_b128 v[96:99], v14 offset:3072
    s_waitcnt lgkmcnt(0)
Lf_84:
    s_waitcnt lgkmcnt(3)
    v_mfma_f32_32x32x16_bf16 v[32:47], v[88:91], v[92:95], v[32:47]
    buffer_load_dwordx4 v[116:119], v4, s[56:59], s81 offen offset:0 sc1
    v_mfma_f32_32x32x16_bf16 v[48:63], v[200:203], v[80:83], v[48:63]
    ds_read_b64_tr_b16 v[72:73], v12 offset:22528
    ds_read_b64_tr_b16 v[74:75], v12 offset:22784
    s_nop 7
    v_mul_f32 v92, v32, v32
    v_mul_f32 v93, v33, v33
    v_mul_f32 v94, v34, v34
    v_mul_f32 v95, v35, v35
    s_waitcnt lgkmcnt(4)
    v_fma_f32 v92, v92, v97, v96
    v_mfma_f32_32x32x16_bf16 v[48:63], v[204:207], v[84:87], v[48:63]
    ds_read_b64_tr_b16 v[76:77], v12 offset:23552
    ds_read_b64_tr_b16 v[78:79], v12 offset:23808
    v_fma_f32 v93, v93, v97, v96
    v_fma_f32 v94, v94, v97, v96
    v_fma_f32 v95, v95, v97, v96
    v_mul_f32 v92, v92, v32
    v_mul_f32 v93, v93, v33
    s_setprio 1
    v_mfma_f32_32x32x16_bf16 v[48:63], v[208:211], v[64:67], v[48:63]
    ds_read_b64_tr_b16 v[80:81], v12 offset:24576
    ds_read_b64_tr_b16 v[82:83], v12 offset:24832
    v_mul_f32 v94, v94, v34
    v_mul_f32 v95, v95, v35
    v_exp_f32 v92, v92
    v_mul_f32 v40, v40, v32
    v_exp_f32 v93, v93
    s_waitcnt lgkmcnt(6)
    v_mfma_f32_32x32x16_bf16 v[48:63], v[212:215], v[68:71], v[48:63]
    ds_read_b64_tr_b16 v[84:85], v12 offset:25600
    ds_read_b64_tr_b16 v[86:87], v12 offset:25856
    v_mul_f32 v41, v41, v33
    v_exp_f32 v94, v94
    v_mul_f32 v42, v42, v34
    v_exp_f32 v95, v95
    v_mul_f32 v43, v43, v35
    buffer_load_dwordx4 v[120:123], v4, s[56:59], s81 offen offset:1024 sc1
    s_waitcnt lgkmcnt(6)
    v_mfma_f32_32x32x16_bf16 v[48:63], v[216:219], v[72:75], v[48:63]
    ds_read_b64_tr_b16 v[64:65], v12 offset:26624
    ds_read_b64_tr_b16 v[66:67], v12 offset:26880
    v_fma_f32 v92, v92, v98, v98
    v_fma_f32 v93, v93, v98, v98
    v_fma_f32 v94, v94, v98, v98
    v_fma_f32 v95, v95, v98, v98
    v_rcp_f32 v92, v92
    s_waitcnt lgkmcnt(6)
    v_mfma_f32_32x32x16_bf16 v[48:63], v[220:223], v[76:79], v[48:63]
    ds_read_b64_tr_b16 v[68:69], v12 offset:27648
    ds_read_b64_tr_b16 v[70:71], v12 offset:27904
    v_rcp_f32 v93, v93
    v_rcp_f32 v94, v94
    v_rcp_f32 v95, v95
    v_mul_f32 v40, v40, v92
    v_mul_f32 v41, v41, v93
    s_setprio 0
    s_waitcnt lgkmcnt(6)
    v_mfma_f32_32x32x16_bf16 v[48:63], v[224:227], v[80:83], v[48:63]
    ds_read_b64_tr_b16 v[72:73], v12 offset:28672
    ds_read_b64_tr_b16 v[74:75], v12 offset:28928
    v_mul_f32 v42, v42, v94
    v_mul_f32 v43, v43, v95
    v_mul_f32 v92, v36, v36
    v_mul_f32 v93, v37, v37
    v_mul_f32 v94, v38, v38
    s_waitcnt lgkmcnt(6)
    v_mfma_f32_32x32x16_bf16 v[48:63], v[228:231], v[84:87], v[48:63]
    ds_read_b64_tr_b16 v[76:77], v12 offset:29696
    ds_read_b64_tr_b16 v[78:79], v12 offset:29952
    ds_read_b32 v10, v3 offset:108
    v_mul_f32 v95, v39, v39
    v_fma_f32 v92, v92, v97, v96
    v_fma_f32 v93, v93, v97, v96
    v_fma_f32 v94, v94, v97, v96
    v_fma_f32 v95, v95, v97, v96
    s_waitcnt lgkmcnt(7)
    v_mfma_f32_32x32x16_bf16 v[48:63], v[232:235], v[64:67], v[48:63]
    ds_read_b64_tr_b16 v[80:81], v12 offset:30720
    ds_read_b64_tr_b16 v[82:83], v12 offset:30976
    v_mul_f32 v92, v92, v36
    v_mul_f32 v93, v93, v37
    v_mul_f32 v94, v94, v38
    v_mul_f32 v95, v95, v39
    v_exp_f32 v92, v92
    s_waitcnt lgkmcnt(7)
    v_mfma_f32_32x32x16_bf16 v[48:63], v[236:239], v[68:71], v[48:63]
    ds_read_b64_tr_b16 v[84:85], v12 offset:31744
    ds_read_b64_tr_b16 v[86:87], v12 offset:32000
    v_mul_f32 v44, v44, v36
    v_exp_f32 v93, v93
    v_mul_f32 v45, v45, v37
    v_exp_f32 v94, v94
    v_mul_f32 v46, v46, v38
    s_waitcnt vmcnt(2)
    s_mov_b64 exec, 1
    ds_add_rtn_u32 v13, v3, v5 offset:52
    s_mov_b64 exec, -1
    s_setprio 2
    s_waitcnt lgkmcnt(8)
    v_mfma_f32_32x32x16_bf16 v[48:63], v[240:243], v[72:75], v[48:63]
    s_waitcnt lgkmcnt(5)
    v_readfirstlane_b32 s11, v10
    s_cmp_ge_u32 s11, 4
    s_cbranch_scc1 Lxl_87
    s_mov_b32 s66, 0
Lsp_88:
    ds_read_b32 v6, v3 offset:108
    s_add_u32 s66, s66, 1
    s_cmp_gt_u32 s66, 8000000
    s_waitcnt lgkmcnt(0)
    s_cbranch_scc1 Lsd_89
    v_readfirstlane_b32 s11, v6
    s_cmp_ge_u32 s11, 4
    s_cbranch_scc0 Lsp_88
Lsd_89:
Lxl_87:
    ds_read_b64_tr_b16 v[64:65], v12 offset:32768
    ds_read_b64_tr_b16 v[66:67], v12 offset:33024
    v_exp_f32 v95, v95
    v_mul_f32 v47, v47, v39
    v_fma_f32 v92, v92, v98, v98
    v_fma_f32 v93, v93, v98, v98
    v_fma_f32 v94, v94, v98, v98
    v_mfma_f32_32x32x16_bf16 v[48:63], v[244:247], v[76:79], v[48:63]
    ds_read_b64_tr_b16 v[68:69], v12 offset:33792
    ds_read_b64_tr_b16 v[70:71], v12 offset:34048
    v_fma_f32 v95, v95, v98, v98
    v_rcp_f32 v92, v92
    v_rcp_f32 v93, v93
    v_rcp_f32 v94, v94
    v_rcp_f32 v95, v95
    ds_read_b32 v10, v3 offset:124
    s_waitcnt lgkmcnt(8)
    v_mfma_f32_32x32x16_bf16 v[48:63], v[248:251], v[80:83], v[48:63]
    ds_read_b64_tr_b16 v[72:73], v12 offset:34816
    ds_read_b64_tr_b16 v[74:75], v12 offset:35072
    v_mul_f32 v44, v44, v92
    v_mul_f32 v45, v45, v93
    v_mul_f32 v46, v46, v94
    v_mul_f32 v47, v47, v95
    v_cvt_pk_bf16_f32 v32, v40, v44
    s_waitcnt lgkmcnt(8)
    v_mfma_f32_32x32x16_bf16 v[48:63], v[252:255], v[84:87], v[48:63]
    ds_read_b64_tr_b16 v[76:77], v12 offset:35840
    ds_read_b64_tr_b16 v[78:79], v12 offset:36096
    v_cvt_pk_bf16_f32 v33, v41, v45
    v_cvt_pk_bf16_f32 v34, v42, v46
    v_cvt_pk_bf16_f32 v35, v43, v47
    buffer_store_dwordx4 v[32:35], v15, s[48:51], s69 offen sc1
    s_add_u32 s69, s69, 114688
    s_waitcnt lgkmcnt(9)
    v_readfirstlane_b32 s11, v13
    s_add_u32 s60, s72, 0
    s_cmp_lg_u32 s11, 6
    s_cbranch_scc1 Lsa_90
    v_mul_u32_u24 v7, 512, v1
    v_add_u32 v7, s60, v7
    v_mov_b32 v6, s100
    s_mov_b64 exec, 0xf
    global_atomic_swap v7, v6, s[4:5] sc1
    s_mov_b64 exec, -1
Lsa_90:
    s_waitcnt lgkmcnt(4)
    v_readfirstlane_b32 s11, v10
    s_cmp_ge_u32 s11, 1
    s_cbranch_scc1 Lws_91
    s_mov_b32 s66, 0
Lsp_92:
    ds_read_b32 v6, v3 offset:124
    s_add_u32 s66, s66, 1
    s_cmp_gt_u32 s66, 8000000
    s_waitcnt lgkmcnt(0)
    s_cbranch_scc1 Lsd_93
    v_readfirstlane_b32 s11, v6
    s_cmp_ge_u32 s11, 1
    s_cbranch_scc0 Lsp_92
Lsd_93:
Lws_91:
    s_setprio 1
    v_mfma_f32_32x32x16_bf16 v[16:31], v[128:131], v[64:67], 0
    ds_read_b64_tr_b16 v[80:81], v12 offset:36864
    ds_read_b64_tr_b16 v[82:83], v12 offset:37120
    ds_read_b32 v10, v3 offset:48
    ds_read_b128 v[92:95], v14 offset:1536
    ds_read_b128 v[96:99], v14 offset:3584
    buffer_load_dwordx4 v[32:35], v4, s[56:59], s81 offen offset:2048 sc1
    v_mfma_f32_32x32x16_bf16 v[16:31], v[132:135], v[68:71], v[16:31]
    ds_read_b64_tr_b16 v[84:85], v12 offset:37888
    ds_read_b64_tr_b16 v[86:87], v12 offset:38144
    s_waitcnt lgkmcnt(4)
    v_readfirstlane_b32 s11, v10
    s_cmp_ge_u32 s11, 3
    s_cbranch_scc1 Lf_95
    s_mov_b32 s66, 0
Lsp_96:
    ds_read_b32 v6, v3 offset:48
    s_add_u32 s66, s66, 1
    s_cmp_gt_u32 s66, 8000000
    s_waitcnt lgkmcnt(0)
    s_cbranch_scc1 Lsd_97
    v_readfirstlane_b32 s11, v6
    s_cmp_ge_u32 s11, 3
    s_cbranch_scc0 Lsp_96
Lsd_97:
    ds_read_b128 v[92:95], v14 offset:1536
    ds_read_b128 v[96:99], v14 offset:3584
    s_waitcnt lgkmcnt(0)
Lf_95:
    s_waitcnt lgkmcnt(3)
    v_mfma_f32_32x32x16_bf16 v[48:63], v[88:91], v[92:95], v[48:63]
    ds_read_b128 v[128:131], v11 offset:0
    v_mfma_f32_32x32x16_bf16 v[16:31], v[136:139], v[72:75], v[16:31]
    ds_read_b64_tr_b16 v[64:65], v12 offset:38912
    ds_read_b64_tr_b16 v[66:67], v12 offset:39168
    s_nop 7
    v_mul_f32 v92, v48, v48
    v_mul_f32 v93, v49, v49
    v_mul_f32 v94, v50, v50
    v_mul_f32 v95, v51, v51
    ds_read_b128 v[132:135], v11 offset:1024
    buffer_load_dwordx4 v[36:39], v4, s[56:59], s81 offen offset:3072 sc1
    v_mfma_f32_32x32x16_bf16 v[16:31], v[140:143], v[76:79], v[16:31]
    ds_read_b64_tr_b16 v[68:69], v12 offset:39936
    ds_read_b64_tr_b16 v[70:71], v12 offset:40192
    s_waitcnt lgkmcnt(8)
    v_fma_f32 v92, v92, v97, v96
    v_fma_f32 v93, v93, v97, v96
    v_fma_f32 v94, v94, v97, v96
    v_fma_f32 v95, v95, v97, v96
    ds_read_b128 v[136:139], v11 offset:2048
    s_setprio 0
    v_mfma_f32_32x32x16_bf16 v[16:31], v[144:147], v[80:83], v[16:31]
    ds_read_b64_tr_b16 v[72:73], v12 offset:40960
    ds_read_b64_tr_b16 v[74:75], v12 offset:41216
    v_mul_f32 v92, v92, v48
    v_mul_f32 v93, v93, v49
    v_mul_f32 v94, v94, v50
    v_mul_f32 v95, v95, v51
    ds_read_b128 v[140:143], v11 offset:3072
    buffer_load_dwordx4 v[40:43], v4, s[56:59], s82 offen offset:0 sc1
    s_waitcnt lgkmcnt(10)
    v_mfma_f32_32x32x16_bf16 v[16:31], v[148:151], v[84:87], v[16:31]
    ds_read_b64_tr_b16 v[76:77], v12 offset:41984
    ds_read_b64_tr_b16 v[78:79], v12 offset:42240
    v_exp_f32 v92, v92
    v_mul_f32 v56, v56, v48
    v_exp_f32 v93, v93
    v_mul_f32 v57, v57, v49
    ds_read_b128 v[144:147], v11 offset:4096
    s_waitcnt lgkmcnt(10)
    v_mfma_f32_32x32x16_bf16 v[16:31], v[152:155], v[64:67], v[16:31]
    ds_read_b64_tr_b16 v[80:81], v12 offset:43008
    ds_read_b64_tr_b16 v[82:83], v12 offset:43264
    v_exp_f32 v94, v94
    v_mul_f32 v58, v58, v50
    v_exp_f32 v95, v95
    v_mul_f32 v59, v59, v51
    ds_read_b128 v[148:151], v11 offset:5120
    buffer_load_dwordx4 v[44:47], v4, s[56:59], s82 offen offset:1024 sc1
    s_waitcnt lgkmcnt(10)
    v_mfma_f32_32x32x16_bf16 v[16:31], v[156:159], v[68:71], v[16:31]
    ds_read_b64_tr_b16 v[84:85], v12 offset:44032
    ds_read_b64_tr_b16 v[86:87], v12 offset:44288
    v_fma_f32 v92, v92, v98, v98
    v_fma_f32 v93, v93, v98, v98
    v_fma_f32 v94, v94, v98, v98
    v_fma_f32 v95, v95, v98, v98
    ds_read_b128 v[152:155], v11 offset:6144
    s_setprio 2
    s_waitcnt lgkmcnt(10)
    v_mfma_f32_32x32x16_bf16 v[16:31], v[160:163], v[72:75], v[16:31]
    ds_read_b64_tr_b16 v[64:65], v12 offset:45056
    ds_read_b64_tr_b16 v[66:67], v12 offset:45312
    v_rcp_f32 v92, v92
    v_rcp_f32 v93, v93
    v_rcp_f32 v94, v94
    v_rcp_f32 v95, v95
    ds_read_b128 v[156:159], v11 offset:7168
    s_waitcnt lgkmcnt(10)
    v_mfma_f32_32x32x16_bf16 v[16:31], v[164:167], v[76:79], v[16:31]
    ds_read_b64_tr_b16 v[68:69], v12 offset:46080
    ds_read_b64_tr_b16 v[70:71], v12 offset:46336
    v_mul_f32 v56, v56, v92
    v_mul_f32 v57, v57, v93
    v_mul_f32 v58, v58, v94
    v_mul_f32 v59, v59, v95
    s_waitcnt vmcnt(4)
    s_mov_b64 exec, 1
    ds_add_rtn_u32 v13, v3, v5 offset:56
    s_mov_b64 exec, -1
    ds_read_b128 v[160:163], v11 offset:8192
    s_waitcnt lgkmcnt(11)
    v_mfma_f32_32x32x16_bf16 v[16:31], v[168:171], v[80:83], v[16:31]
    ds_read_b64_tr_b16 v[72:73], v12 offset:47104
    ds_read_b64_tr_b16 v[74:75], v12 offset:47360
    v_mul_f32 v92, v52, v52
    v_mul_f32 v93, v53, v53
    v_mul_f32 v94, v54, v54
    v_mul_f32 v95, v55, v55
    buffer_load_dwordx4 v[164:167], v4, s[56:59], s84 offen offset:3072 sc1
    s_waitcnt lgkmcnt(10)
    v_mfma_f32_32x32x16_bf16 v[16:31], v[172:175], v[84:87], v[16:31]
    ds_read_b64_tr_b16 v[76:77], v12 offset:48128
    ds_read_b64_tr_b16 v[78:79], v12 offset:48384
    v_fma_f32 v92, v92, v97, v96
    v_fma_f32 v93, v93, v97, v96
    v_fma_f32 v94, v94, v97, v96
    v_fma_f32 v95, v95, v97, v96
    s_setprio 1
    s_waitcnt lgkmcnt(9)
    v_mfma_f32_32x32x16_bf16 v[16:31], v[176:179], v[64:67], v[16:31]
    ds_read_b64_tr_b16 v[80:81], v12 offset:49152
    ds_read_b64_tr_b16 v[82:83], v12 offset:49408
    v_mul_f32 v92, v92, v52
    v_mul_f32 v93, v93, v53
    v_mul_f32 v94, v94, v54
    v_mul_f32 v95, v95, v55
    buffer_load_dwordx4 v[168:171], v4, s[56:59], s85 offen offset:0 sc1
    s_waitcnt lgkmcnt(8)
    v_mfma_f32_32x32x16_bf16 v[16:31], v[180:183], v[68:71], v[16:31]
    ds_read_b64_tr_b16 v[84:85], v12 offset:50176
    ds_read_b64_tr_b16 v[86:87], v12 offset:50432
    v_exp_f32 v92, v92
    v_mul_f32 v60, v60, v52
    v_exp_f32 v93, v93
    v_mul_f32 v61, v61, v53
    s_waitcnt lgkmcnt(9)
    v_readfirstlane_b32 s11, v13
    s_add_u32 s60, s72, 128
    s_cmp_lg_u32 s11, 6
    s_cbranch_scc1 Lsa_98
    v_mul_u32_u24 v7, 512, v1
    v_add_u32 v7, s60, v7
    v_mov_b32 v6, s100
    s_mov_b64 exec, 0xf
    global_atomic_swap v7, v6, s[4:5] sc1
    s_mov_b64 exec, -1
Lsa_98:
    s_mov_b64 exec, 1
    ds_add_u32 v3, v5 offset:128
    s_mov_b64 exec, -1
    buffer_load_dwordx4 v[172:175], v4, s[56:59], s85 offen offset:1024 sc1
    s_waitcnt lgkmcnt(7)
    v_mfma_f32_32x32x16_bf16 v[16:31], v[184:187], v[72:75], v[16:31]
    ds_read_b64_tr_b16 v[64:65], v12 offset:51200
    ds_read_b64_tr_b16 v[66:67], v12 offset:51456
    v_exp_f32 v94, v94
    v_mul_f32 v62, v62, v54
    v_exp_f32 v95, v95
    v_mul_f32 v63, v63, v55
    buffer_load_dwordx4 v[176:179], v4, s[56:59], s85 offen offset:2048 sc1
    s_waitcnt lgkmcnt(7)
    v_mfma_f32_32x32x16_bf16 v[16:31], v[188:191], v[76:79], v[16:31]
    ds_read_b64_tr_b16 v[68:69], v12 offset:52224
    ds_read_b64_tr_b16 v[70:71], v12 offset:52480
    v_fma_f32 v92, v92, v98, v98
    v_fma_f32 v93, v93, v98, v98
    v_fma_f32 v94, v94, v98, v98
    v_fma_f32 v95, v95, v98, v98
    s_setprio 0
    s_waitcnt lgkmcnt(7)
    v_mfma_f32_32x32x16_bf16 v[16:31], v[192:195], v[80:83], v[16:31]
    ds_read_b64_tr_b16 v[72:73], v12 offset:53248
    ds_read_b64_tr_b16 v[74:75], v12 offset:53504
    v_rcp_f32 v92, v92
    v_rcp_f32 v93, v93
    v_rcp_f32 v94, v94
    v_rcp_f32 v95, v95
    buffer_load_dwordx4 v[180:183], v4, s[56:59], s85 offen offset:3072 sc1
    s_waitcnt lgkmcnt(7)
    v_mfma_f32_32x32x16_bf16 v[16:31], v[196:199], v[84:87], v[16:31]
    ds_read_b64_tr_b16 v[76:77], v12 offset:54272
    ds_read_b64_tr_b16 v[78:79], v12 offset:54528
    v_mul_f32 v60, v60, v92
    v_mul_f32 v61, v61, v93
    v_mul_f32 v62, v62, v94
    v_mul_f32 v63, v63, v95
    buffer_load_dwordx4 v[184:187], v4, s[56:59], s86 offen offset:0 sc1
    s_waitcnt lgkmcnt(6)
    v_mfma_f32_32x32x16_bf16 v[16:31], v[200:203], v[64:67], v[16:31]
    ds_read_b64_tr_b16 v[80:81], v12 offset:55296
    ds_read_b64_tr_b16 v[82:83], v12 offset:55552
    v_cvt_pk_bf16_f32 v48, v56, v60
    v_cvt_pk_bf16_f32 v49, v57, v61
    v_cvt_pk_bf16_f32 v50, v58, v62
    v_cvt_pk_bf16_f32 v51, v59, v63
    buffer_store_dwordx4 v[48:51], v15, s[48:51], s69 offen sc1
    s_add_u32 s69, s69, 114688
    buffer_load_dwordx4 v[188:191], v4, s[56:59], s86 offen offset:1024 sc1
    s_waitcnt lgkmcnt(6)
    v_mfma_f32_32x32x16_bf16 v[16:31], v[204:207], v[68:71], v[16:31]
    ds_read_b64_tr_b16 v[84:85], v12 offset:56320
    ds_read_b64_tr_b16 v[86:87], v12 offset:56576
    s_setprio 2
    s_waitcnt lgkmcnt(6)
    v_mfma_f32_32x32x16_bf16 v[16:31], v[208:211], v[72:75], v[16:31]
    ds_read_b64_tr_b16 v[64:65], v12 offset:57344
    ds_read_b64_tr_b16 v[66:67], v12 offset:57600
    buffer_load_dwordx4 v[192:195], v4, s[56:59], s86 offen offset:2048 sc1
    s_waitcnt lgkmcnt(6)
    v_mfma_f32_32x32x16_bf16 v[16:31], v[212:215], v[76:79], v[16:31]
    ds_read_b64_tr_b16 v[68:69], v12 offset:58368
    ds_read_b64_tr_b16 v[70:71], v12 offset:58624
    buffer_load_dwordx4 v[196:199], v4, s[56:59], s86 offen offset:3072 sc1
    ds_read_b32 v10, v3 offset:68
    s_waitcnt lgkmcnt(7)
    v_mfma_f32_32x32x16_bf16 v[16:31], v[216:219], v[80:83], v[16:31]
    ds_read_b64_tr_b16 v[72:73], v12 offset:59392
    ds_read_b64_tr_b16 v[74:75], v12 offset:59648
    v_add_u32 v8, 0x10000, v8
    ds_read_b64_tr_b16 v[96:97], v8 offset:0
    buffer_load_dwordx4 v[200:203], v4, s[56:59], s87 offen offset:0 sc1
    s_waitcnt lgkmcnt(8)
    v_mfma_f32_32x32x16_bf16 v[16:31], v[220:223], v[84:87], v[16:31]
    ds_read_b64_tr_b16 v[76:77], v12 offset:60416
    ds_read_b64_tr_b16 v[78:79], v12 offset:60672
    s_setprio 1
    s_waitcnt lgkmcnt(8)
    v_mfma_f32_32x32x16_bf16 v[16:31], v[224:227], v[64:67], v[16:31]
    ds_read_b64_tr_b16 v[80:81], v12 offset:61440
    ds_read_b64_tr_b16 v[82:83], v12 offset:61696
    s_waitcnt lgkmcnt(7)
    v_readfirstlane_b32 s11, v10
    s_cmp_ge_u32 s11, 1
    s_cbranch_scc1 Ls0_99
    s_mov_b32 s66, 0
Lsp_100:
    ds_read_b32 v6, v3 offset:68
    s_add_u32 s66, s66, 1
    s_cmp_gt_u32 s66, 8000000
    s_waitcnt lgkmcnt(0)
    s_cbranch_scc1 Lsd_101
    v_readfirstlane_b32 s11, v6
    s_cmp_ge_u32 s11, 1
    s_cbranch_scc0 Lsp_100
Lsd_101:
Ls0_99:
    s_mov_b32 s61, 0
    buffer_load_dwordx4 v[216:219], v4, s[52:55], s61 offen offset:0 sc1
    v_mfma_f32_32x32x16_bf16 v[16:31], v[228:231], v[68:71], v[16:31]
    ds_read_b64_tr_b16 v[84:85], v12 offset:62464
    ds_read_b64_tr_b16 v[86:87], v12 offset:62720
    s_waitcnt lgkmcnt(6)
    v_lshlrev_b32 v92, 16, v96
    v_and_b32 v93, s10, v96
    v_lshlrev_b32 v94, 16, v97
    v_and_b32 v95, s10, v97
    ds_write_b128 v9, v[92:95] offset:8192
    buffer_load_dwordx4 v[220:223], v4, s[52:55], s61 offen offset:1024 sc1
    v_mfma_f32_32x32x16_bf16 v[16:31], v[232:235], v[72:75], v[16:31]
    ds_read_b64_tr_b16 v[64:65], v12 offset:63488
    ds_read_b64_tr_b16 v[66:67], v12 offset:63744
    buffer_load_dwordx4 v[224:227], v4, s[52:55], s61 offen offset:2048 sc1
    s_waitcnt lgkmcnt(7)
    v_mfma_f32_32x32x16_bf16 v[16:31], v[236:239], v[76:79], v[16:31]
    ds_read_b64_tr_b16 v[68:69], v12 offset:64512
    ds_read_b64_tr_b16 v[70:71], v12 offset:64768
    ds_read_b64_tr_b16 v[96:97], v8 offset:32768
    buffer_load_dwordx4 v[228:231], v4, s[52:55], s61 offen offset:3072 sc1
    s_setprio 0
    s_waitcnt lgkmcnt(8)
    v_mfma_f32_32x32x16_bf16 v[16:31], v[240:243], v[80:83], v[16:31]
    s_mov_b32 s61, 4096
    buffer_load_dwordx4 v[232:235], v4, s[52:55], s61 offen offset:0 sc1
    s_waitcnt lgkmcnt(6)
    v_mfma_f32_32x32x16_bf16 v[16:31], v[244:247], v[84:87], v[16:31]
    buffer_load_dwordx4 v[236:239], v4, s[52:55], s61 offen offset:1024 sc1
    s_waitcnt lgkmcnt(3)
    v_mfma_f32_32x32x16_bf16 v[16:31], v[248:251], v[64:67], v[16:31]
    s_waitcnt lgkmcnt(0)
    v_lshlrev_b32 v92, 16, v96
    v_and_b32 v93, s10, v96
    v_lshlrev_b32 v94, 16, v97
    v_and_b32 v95, s10, v97
    ds_write_b128 v9, v[92:95] offset:12288
    buffer_load_dwordx4 v[240:243], v4, s[52:55], s61 offen offset:2048 sc1
    v_mfma_f32_32x32x16_bf16 v[16:31], v[252:255], v[68:71], v[16:31]
    buffer_load_dwordx4 v[244:247], v4, s[52:55], s61 offen offset:3072 sc1
    s_setprio 2
    ds_read_b32 v10, v3 offset:48
    ds_read_b128 v[92:95], v14 offset:2048
    ds_read_b128 v[96:99], v14 offset:4096
    s_waitcnt vmcnt(12)
    s_mov_b64 exec, 1
    ds_add_rtn_u32 v13, v3, v5 offset:60
    s_mov_b64 exec, -1
    s_waitcnt lgkmcnt(3)
    v_readfirstlane_b32 s11, v10
    s_cmp_ge_u32 s11, 4
    s_cbranch_scc1 Lf_102
    s_mov_b32 s66, 0
Lsp_103:
    ds_read_b32 v6, v3 offset:48
    s_add_u32 s66, s66, 1
    s_cmp_gt_u32 s66, 8000000
    s_waitcnt lgkmcnt(0)
    s_cbranch_scc1 Lsd_104
    v_readfirstlane_b32 s11, v6
    s_cmp_ge_u32 s11, 4
    s_cbranch_scc0 Lsp_103
Lsd_104:
    ds_read_b128 v[92:95], v14 offset:2048
    ds_read_b128 v[96:99], v14 offset:4096
    s_waitcnt lgkmcnt(0)
Lf_102:
    s_waitcnt lgkmcnt(2)
    v_mfma_f32_32x32x16_bf16 v[16:31], v[88:91], v[92:95], v[16:31]
    s_waitcnt lgkmcnt(0)
    v_readfirstlane_b32 s11, v13
    s_add_u32 s60, s72, 256
    s_cmp_lg_u32 s11, 6
    s_cbranch_scc1 Lsa_105
    v_mul_u32_u24 v7, 512, v1
    v_add_u32 v7, s60, v7
    v_mov_b32 v6, s100
    s_mov_b64 exec, 0xf
    global_atomic_swap v7, v6, s[4:5] sc1
    s_mov_b64 exec, -1
Lsa_105:
    s_nop 0
    v_pk_mul_f32 v[92:93], v[16:17], v[16:17]
    v_pk_mul_f32 v[94:95], v[18:19], v[18:19]
    v_pk_fma_f32 v[92:93], v[92:93], v[96:97], v[96:97] op_sel:[0,1,0] op_sel_hi:[1,1,0]
    v_pk_fma_f32 v[94:95], v[94:95], v[96:97], v[96:97] op_sel:[0,1,0] op_sel_hi:[1,1,0]
    v_pk_mul_f32 v[92:93], v[92:93], v[16:17]
    v_pk_mul_f32 v[94:95], v[94:95], v[18:19]
    v_exp_f32 v92, v92
    v_exp_f32 v93, v93
    v_exp_f32 v94, v94
    v_exp_f32 v95, v95
    v_pk_mul_f32 v[24:25], v[24:25], v[16:17]
    v_pk_mul_f32 v[26:27], v[26:27], v[18:19]
    v_pk_fma_f32 v[92:93], v[92:93], v[98:99], v[98:99] op_sel:[0,0,0] op_sel_hi:[1,0,0]
    v_pk_fma_f32 v[94:95], v[94:95], v[98:99], v[98:99] op_sel:[0,0,0] op_sel_hi:[1,0,0]
    v_rcp_f32 v92, v92
    v_rcp_f32 v93, v93
    v_rcp_f32 v94, v94
    v_rcp_f32 v95, v95
    v_pk_mul_f32 v[24:25], v[24:25], v[92:93]
    v_pk_mul_f32 v[26:27], v[26:27], v[94:95]
    v_pk_mul_f32 v[92:93], v[20:21], v[20:21]
    v_pk_mul_f32 v[94:95], v[22:23], v[22:23]
    v_pk_fma_f32 v[92:93], v[92:93], v[96:97], v[96:97] op_sel:[0,1,0] op_sel_hi:[1,1,0]
    v_pk_fma_f32 v[94:95], v[94:95], v[96:97], v[96:97] op_sel:[0,1,0] op_sel_hi:[1,1,0]
    v_pk_mul_f32 v[92:93], v[92:93], v[20:21]
    v_pk_mul_f32 v[94:95], v[94:95], v[22:23]
    v_exp_f32 v92, v92
    v_exp_f32 v93, v93
    v_exp_f32 v94, v94
    v_exp_f32 v95, v95
    v_pk_mul_f32 v[28:29], v[28:29], v[20:21]
    v_pk_mul_f32 v[30:31], v[30:31], v[22:23]
    v_pk_fma_f32 v[92:93], v[92:93], v[98:99], v[98:99] op_sel:[0,0,0] op_sel_hi:[1,0,0]
    v_pk_fma_f32 v[94:95], v[94:95], v[98:99], v[98:99] op_sel:[0,0,0] op_sel_hi:[1,0,0]
    v_rcp_f32 v92, v92
    v_rcp_f32 v93, v93
    v_rcp_f32 v94, v94
    v_rcp_f32 v95, v95
    v_pk_mul_f32 v[28:29], v[28:29], v[92:93]
    v_pk_mul_f32 v[30:31], v[30:31], v[94:95]
    v_cvt_pk_bf16_f32 v16, v24, v28
    v_cvt_pk_bf16_f32 v17, v25, v29
    v_cvt_pk_bf16_f32 v18, v26, v30
    v_cvt_pk_bf16_f32 v19, v27, v31
    buffer_store_dwordx4 v[16:19], v15, s[48:51], s69 offen sc1
    s_add_u32 s64, s72, 384
    s_waitcnt vmcnt(0)
    s_mov_b64 exec, 1
    ds_add_rtn_u32 v6, v3, v5 offset:64
    s_mov_b64 exec, -1
    s_waitcnt lgkmcnt(0)
    v_readfirstlane_b32 s11, v6
    s_cmp_lg_u32 s11, 6
    s_cbranch_scc1 Lar_106
    v_mul_u32_u24 v7, 512, v1
    v_add_u32 v7, s64, v7
    v_mov_b32 v6, s100
    s_mov_b64 exec, 0xf
    global_atomic_swap v7, v6, s[4:5] sc1
    s_mov_b64 exec, -1
Lar_106:
    s_setprio 2
    buffer_load_dwordx4 v[204:207], v4, s[56:59], s87 offen offset:1024 sc1
    buffer_load_dwordx4 v[208:211], v4, s[56:59], s87 offen offset:2048 sc1
    buffer_load_dwordx4 v[212:215], v4, s[56:59], s87 offen offset:3072 sc1
    s_mov_b32 s66, 0
Lsp_107:
    ds_read_b32 v6, v3 offset:68
    s_add_u32 s66, s66, 1
    s_cmp_gt_u32 s66, 8000000
    s_waitcnt lgkmcnt(0)
    s_cbranch_scc1 Lsd_108
    v_readfirstlane_b32 s11, v6
    s_cmp_ge_u32 s11, 2
    s_cbranch_scc0 Lsp_107
Lsd_108:
    s_mov_b32 s60, 114688
    buffer_load_dwordx4 v[64:67], v4, s[52:55], s60 offen offset:0 sc1
    buffer_load_dwordx4 v[68:71], v4, s[52:55], s60 offen offset:1024 sc1
    buffer_load_dwordx4 v[72:75], v4, s[52:55], s60 offen offset:2048 sc1
    buffer_load_dwordx4 v[76:79], v4, s[52:55], s60 offen offset:3072 sc1
    s_mov_b32 s60, 118784
    buffer_load_dwordx4 v[80:83], v4, s[52:55], s60 offen offset:0 sc1
    buffer_load_dwordx4 v[84:87], v4, s[52:55], s60 offen offset:1024 sc1
    buffer_load_dwordx4 v[88:91], v4, s[52:55], s60 offen offset:2048 sc1
    buffer_load_dwordx4 v[92:95], v4, s[52:55], s60 offen offset:3072 sc1
    s_branch L_p4
L_help:
    s_setprio 3
    s_lshr_b32 s70, s9, 2
    s_and_b32 s70, s70, 1
    s_and_b32 s71, s9, 3
    s_lshr_b32 s60, s9, 3
    s_lshl_b32 s60, s60, 2
    s_add_u32 s71, s71, s60
    s_mul_i32 s60, s71, 229376
    s_lshl_b32 s61, s3, 15
    s_add_u32 s60, s60, s61
    s_add_u32 s56, s4, 0xa1c000
    s_addc_u32 s57, s5, 0
    s_add_u32 s56, s56, s60
    s_addc_u32 s57, s57, 0
    s_mov_b32 s58, 0x8000
    s_mov_b32 s59, 0x20000
    s_mov_b32 s81, 4096
    s_mov_b32 s82, 8192
    s_mov_b32 s83, 12288
    s_mov_b32 s84, 16384
    s_mov_b32 s85, 20480
    s_mov_b32 s86, 24576
    s_mov_b32 s87, 28672
    s_mov_b32 s89, 0x3b000000
    s_lshl_b32 s60, s9, 9
    s_and_b32 s61, s8, 3
    s_lshl_b32 s61, s61, 7
    s_add_u32 s60, s60, s61
    s_add_u32 s60, s60, 0x12e2000
    s_add_u32 s62, s4, s60
    s_addc_u32 s63, s5, 0
    s_mov_b32 s11, 0
Lpo_109:
    s_add_u32 s11, s11, 1
    s_cmp_gt_u32 s11, 1000000
    s_cbranch_scc1 Lpd_111
    s_load_dwordx16 s[16:31], s[62:63], 0 glc
Lpc_110:
    s_waitcnt lgkmcnt(0)
    s_cmp_eq_u64 s[16:17], s[100:101]
    s_cbranch_scc0 Lpo_109
    s_cmp_eq_u64 s[18:19], s[100:101]
    s_cbranch_scc0 Lpo_109
    s_cmp_eq_u64 s[20:21], s[100:101]
    s_cbranch_scc0 Lpo_109
    s_cmp_eq_u64 s[22:23], s[100:101]
    s_cbranch_scc0 Lpo_109
    s_cmp_eq_u64 s[24:25], s[100:101]
    s_cbranch_scc0 Lpo_109
    s_cmp_eq_u64 s[26:27], s[100:101]
    s_cbranch_scc0 Lpo_109
    s_cmp_eq_u64 s[28:29], s[100:101]
    s_cbranch_scc0 Lpo_109
    s_cmp_eq_u64 s[30:31], s[100:101]
    s_cbranch_scc0 Lpo_109
Lpd_111:
    v_mov_b32 v6, 1
    ds_write_b32 v3, v6 offset:40
    s_lshl_b32 s60, s8, 17
    s_add_u32 s40, s4, 0x42c000
    s_addc_u32 s41, s5, 0
    s_add_u32 s40, s40, s60
    s_addc_u32 s41, s41, 0
    s_mov_b32 s42, 0x20000
    s_mov_b32 s43, 0x20000
    s_lshl_b32 s60, s8, 3
    s_add_u32 s60, s60, s70
    s_mul_i32 s60, s60, 57344
    s_lshl_b32 s61, s3, 13
    s_add_u32 s60, s60, s61
    s_add_u32 s52, s4, 0xbdc000
    s_addc_u32 s53, s5, 0
    s_add_u32 s52, s52, s60
    s_addc_u32 s53, s53, 0
    s_mov_b32 s54, 0x62000
    s_mov_b32 s55, 0x20000
    v_and_b32 v6, 15, v1
    v_lshrrev_b32 v124, 4, v1
    v_xor_b32 v124, v124, v6
    v_lshlrev_b32 v124, 4, v124
    v_lshl_add_u32 v124, v6, 8, v124
    s_lshl_b32 s60, s3, 12
    v_add_u32 v124, s60, v124
    s_and_b32 s60, s3, 3
    s_lshl_b32 s60, s60, 2
    v_bfe_u32 v126, v1, 3, 2
    v_add_u32 v126, s60, v126
    v_and_b32 v125, 6, v1
    v_lshlrev_b32 v125, 1, v125
    v_and_b32 v6, 1, v1
    v_add_u32 v125, v125, v6
    v_lshrrev_b32 v7, 5, v1
    v_lshl_add_u32 v125, v7, 1, v125
    v_xor_b32 v125, v125, v126
    v_lshlrev_b32 v125, 4, v125
    v_lshl_add_u32 v125, v126, 8, v125
    v_and_b32 v6, 7, v1
    v_lshlrev_b32 v126, 10, v126
    v_lshl_add_u32 v126, v6, 4, v126
    v_lshl_add_u32 v126, v7, 3, v126
    v_lshlrev_b32 v127, 5, v6
    v_lshl_add_u32 v127, v7, 2, v127
    v_add_u32 v127, v127, v3
    s_lshl_b32 s88, s8, 17
    s_lshl_b32 s60, s70, 14
    s_add_u32 s88, s88, s60
    s_lshl_b32 s60, s71, 7
    s_add_u32 s88, s88, s60
    v_lshrrev_b32 v7, 5, v1
    v_bfe_u32 v6, v1, 2, 2
    v_lshl_add_u32 v12, v7, 3, v6
    v_lshlrev_b32 v12, 6, v12
    v_and_b32 v13, 16, v1
    v_lshl_add_u32 v12, v13, 1, v12
    v_and_b32 v13, 3, v1
    v_lshl_add_u32 v12, v13, 3, v12
    v_and_b32 v14, 31, v1
    v_lshl_add_u32 v14, v14, 4, v3
    v_cmp_eq_u32 s[74:75], 1, v13
    v_cmp_eq_u32 s[76:77], 2, v13
    v_cmp_eq_u32 s[78:79], 3, v13
    v_mov_b32 v68, 0x3f803f80
    v_mov_b32 v69, 0x3f803f80
    s_mov_b32 s66, 0
Lsp_112:
    ds_read_b32 v6, v3 offset:88
    s_add_u32 s66, s66, 1
    s_cmp_gt_u32 s66, 8000000
    s_waitcnt lgkmcnt(0)
    s_cbranch_scc1 Lsd_113
    v_readfirstlane_b32 s11, v6
    s_cmp_ge_u32 s11, 1
    s_cbranch_scc0 Lsp_112
Lsd_113:
    s_add_u32 s44, s4, 0x414000
    s_addc_u32 s45, s5, 0
    s_mov_b32 s46, 0x18000
    s_mov_b32 s47, 0x20000
    v_lshlrev_b32 v8, 3, v1
    s_lshl_b32 s60, s71, 9
    s_add_u32 s60, s60, 20480
    buffer_load_dword v72, v8, s[44:47], s60 offen sc1
    s_add_u32 s60, s60, 24576
    buffer_load_dword v73, v8, s[44:47], s60 offen sc1
    s_add_u32 s60, s60, 24576
    buffer_load_dword v74, v8, s[44:47], s60 offen sc1
    s_add_u32 s60, s60, 24576
    buffer_load_dword v75, v8, s[44:47], s60 offen sc1
    s_and_b32 s60, s7, 15
    s_lshl_b32 s60, s60, 10
    s_add_u32 s60, s60, 0x12ee000
    s_add_u32 s62, s4, s60
    s_addc_u32 s63, s5, 0
    s_add_u32 s64, s100, 32
    s_mov_b32 s11, 0
Lpo_114:
    s_add_u32 s11, s11, 1
    s_cmp_gt_u32 s11, 1000000
    s_cbranch_scc1 Lpd_116
    s_load_dword s16, s[62:63], 0 glc
    s_load_dword s17, s[62:63], 128 glc
    s_load_dword s18, s[62:63], 256 glc
    s_load_dword s19, s[62:63], 384 glc
    s_load_dword s20, s[62:63], 512 glc
    s_load_dword s21, s[62:63], 640 glc
    s_load_dword s22, s[62:63], 768 glc
    s_load_dword s23, s[62:63], 896 glc
Lpc_115:
    s_waitcnt lgkmcnt(0)
    s_cmp_eq_u32 s16, s64
    s_cbranch_scc0 Lpo_114
    s_cmp_eq_u32 s17, s64
    s_cbranch_scc0 Lpo_114
    s_cmp_eq_u32 s18, s64
    s_cbranch_scc0 Lpo_114
    s_cmp_eq_u32 s19, s64
    s_cbranch_scc0 Lpo_114
    s_cmp_eq_u32 s20, s64
    s_cbranch_scc0 Lpo_114
    s_cmp_eq_u32 s21, s64
    s_cbranch_scc0 Lpo_114
    s_cmp_eq_u32 s22, s64
    s_cbranch_scc0 Lpo_114
    s_cmp_eq_u32 s23, s64
    s_cbranch_scc0 Lpo_114
Lpd_116:
    s_mov_b32 m0, 0x0
    s_mov_b32 s60, 0x0
    buffer_load_dwordx4 v4, s[40:43], s60 offen offset:0 sc1 lds
    buffer_load_dwordx4 v4, s[40:43], s60 offen offset:1024 sc1 lds
    buffer_load_dwordx4 v4, s[40:43], s60 offen offset:2048 sc1 lds
    buffer_load_dwordx4 v4, s[40:43], s60 offen offset:3072 sc1 lds
    s_mov_b32 m0, 0x1000
    s_mov_b32 s60, 0x1000
    buffer_load_dwordx4 v4, s[40:43], s60 offen offset:0 sc1 lds
    buffer_load_dwordx4 v4, s[40:43], s60 offen offset:1024 sc1 lds
    buffer_load_dwordx4 v4, s[40:43], s60 offen offset:2048 sc1 lds
    buffer_load_dwordx4 v4, s[40:43], s60 offen offset:3072 sc1 lds
    s_mov_b32 m0, 0x8000
    s_mov_b32 s60, 0x8000
    buffer_load_dwordx4 v4, s[40:43], s60 offen offset:0 sc1 lds
    buffer_load_dwordx4 v4, s[40:43], s60 offen offset:1024 sc1 lds
    buffer_load_dwordx4 v4, s[40:43], s60 offen offset:2048 sc1 lds
    buffer_load_dwordx4 v4, s[40:43], s60 offen offset:3072 sc1 lds
    s_mov_b32 m0, 0x9000
    s_mov_b32 s60, 0x9000
    buffer_load_dwordx4 v4, s[40:43], s60 offen offset:0 sc1 lds
    buffer_load_dwordx4 v4, s[40:43], s60 offen offset:1024 sc1 lds
    buffer_load_dwordx4 v4, s[40:43], s60 offen offset:2048 sc1 lds
    buffer_load_dwordx4 v4, s[40:43], s60 offen offset:3072 sc1 lds
    s_mov_b32 m0, 0x2000
    s_mov_b32 s60, 0x2000
    buffer_load_dwordx4 v4, s[40:43], s60 offen offset:0 sc1 lds
    buffer_load_dwordx4 v4, s[40:43], s60 offen offset:1024 sc1 lds
    buffer_load_dwordx4 v4, s[40:43], s60 offen offset:2048 sc1 lds
    buffer_load_dwordx4 v4, s[40:43], s60 offen offset:3072 sc1 lds
    s_mov_b32 m0, 0x3000
    s_mov_b32 s60, 0x3000
    buffer_load_dwordx4 v4, s[40:43], s60 offen offset:0 sc1 lds
    buffer_load_dwordx4 v4, s[40:43], s60 offen offset:1024 sc1 lds
    buffer_load_dwordx4 v4, s[40:43], s60 offen offset:2048 sc1 lds
    buffer_load_dwordx4 v4, s[40:43], s60 offen offset:3072 sc1 lds
    s_mov_b32 m0, 0xa000
    s_mov_b32 s60, 0xa000
    buffer_load_dwordx4 v4, s[40:43], s60 offen offset:0 sc1 lds
    buffer_load_dwordx4 v4, s[40:43], s60 offen offset:1024 sc1 lds
    buffer_load_dwordx4 v4, s[40:43], s60 offen offset:2048 sc1 lds
    buffer_load_dwordx4 v4, s[40:43], s60 offen offset:3072 sc1 lds
    s_mov_b32 m0, 0xb000
    s_mov_b32 s60, 0xb000
    buffer_load_dwordx4 v4, s[40:43], s60 offen offset:0 sc1 lds
    buffer_load_dwordx4 v4, s[40:43], s60 offen offset:1024 sc1 lds
    buffer_load_dwordx4 v4, s[40:43], s60 offen offset:2048 sc1 lds
    buffer_load_dwordx4 v4, s[40:43], s60 offen offset:3072 sc1 lds
    s_mov_b32 m0, 0x4000
    s_mov_b32 s60, 0x4000
    buffer_load_dwordx4 v4, s[40:43], s60 offen offset:0 sc1 lds
    buffer_load_dwordx4 v4, s[40:43], s60 offen offset:1024 sc1 lds
    buffer_load_dwordx4 v4, s[40:43], s60 offen offset:2048 sc1 lds
    buffer_load_dwordx4 v4, s[40:43], s60 offen offset:3072 sc1 lds
    s_mov_b32 m0, 0x5000
    s_mov_b32 s60, 0x5000
    buffer_load_dwordx4 v4, s[40:43], s60 offen offset:0 sc1 lds
    buffer_load_dwordx4 v4, s[40:43], s60 offen offset:1024 sc1 lds
    buffer_load_dwordx4 v4, s[40:43], s60 offen offset:2048 sc1 lds
    buffer_load_dwordx4 v4, s[40:43], s60 offen offset:3072 sc1 lds
    s_mov_b32 m0, 0xc000
    s_mov_b32 s60, 0xc000
    buffer_load_dwordx4 v4, s[40:43], s60 offen offset:0 sc1 lds
    buffer_load_dwordx4 v4, s[40:43], s60 offen offset:1024 sc1 lds
    buffer_load_dwordx4 v4, s[40:43], s60 offen offset:2048 sc1 lds
    buffer_load_dwordx4 v4, s[40:43], s60 offen offset:3072 sc1 lds
    s_mov_b32 m0, 0xd000
    s_mov_b32 s60, 0xd000
    buffer_load_dwordx4 v4, s[40:43], s60 offen offset:0 sc1 lds
    buffer_load_dwordx4 v4, s[40:43], s60 offen offset:1024 sc1 lds
    buffer_load_dwordx4 v4, s[40:43], s60 offen offset:2048 sc1 lds
    buffer_load_dwordx4 v4, s[40:43], s60 offen offset:3072 sc1 lds
    s_mov_b32 m0, 0x6000
    s_mov_b32 s60, 0x6000
    buffer_load_dwordx4 v4, s[40:43], s60 offen offset:0 sc1 lds
    buffer_load_dwordx4 v4, s[40:43], s60 offen offset:1024 sc1 lds
    buffer_load_dwordx4 v4, s[40:43], s60 offen offset:2048 sc1 lds
    buffer_load_dwordx4 v4, s[40:43], s60 offen offset:3072 sc1 lds
    s_mov_b32 m0, 0x7000
    s_mov_b32 s60, 0x7000
    buffer_load_dwordx4 v4, s[40:43], s60 offen offset:0 sc1 lds
    buffer_load_dwordx4 v4, s[40:43], s60 offen offset:1024 sc1 lds
    buffer_load_dwordx4 v4, s[40:43], s60 offen offset:2048 sc1 lds
    buffer_load_dwordx4 v4, s[40:43], s60 offen offset:3072 sc1 lds
    s_waitcnt vmcnt(58)
    v_add_f32 v72, v72, v73
    s_waitcnt vmcnt(56)
    v_add_f32 v74, v74, v75
    v_add_f32 v72, v72, v74
    v_cvt_pk_bf16_f32 v72, v72, v72
    v_and_b32 v72, s10, v72
    v_lshl_add_u32 v8, v1, 2, v3
    ds_write_b32 v8, v72 offset:256
    s_waitcnt vmcnt(40)
    s_barrier
    s_mov_b32 m0, 0xe000
    s_mov_b32 s60, 0xe000
    buffer_load_dwordx4 v4, s[40:43], s60 offen offset:0 sc1 lds
    buffer_load_dwordx4 v4, s[40:43], s60 offen offset:1024 sc1 lds
    buffer_load_dwordx4 v4, s[40:43], s60 offen offset:2048 sc1 lds
    buffer_load_dwordx4 v4, s[40:43], s60 offen offset:3072 sc1 lds
    s_mov_b32 m0, 0xf000
    s_mov_b32 s60, 0xf000
    buffer_load_dwordx4 v4, s[40:43], s60 offen offset:0 sc1 lds
    buffer_load_dwordx4 v4, s[40:43], s60 offen offset:1024 sc1 lds
    buffer_load_dwordx4 v4, s[40:43], s60 offen offset:2048 sc1 lds
    buffer_load_dwordx4 v4, s[40:43], s60 offen offset:3072 sc1 lds
    s_mov_b32 m0, 0x10000
    s_mov_b32 s60, 0x10000
    buffer_load_dwordx4 v4, s[40:43], s60 offen offset:0 sc1 lds
    buffer_load_dwordx4 v4, s[40:43], s60 offen offset:1024 sc1 lds
    buffer_load_dwordx4 v4, s[40:43], s60 offen offset:2048 sc1 lds
    buffer_load_dwordx4 v4, s[40:43], s60 offen offset:3072 sc1 lds
    s_mov_b32 m0, 0x11000
    s_mov_b32 s60, 0x11000
    buffer_load_dwordx4 v4, s[40:43], s60 offen offset:0 sc1 lds
    buffer_load_dwordx4 v4, s[40:43], s60 offen offset:1024 sc1 lds
    buffer_load_dwordx4 v4, s[40:43], s60 offen offset:2048 sc1 lds
    buffer_load_dwordx4 v4, s[40:43], s60 offen offset:3072 sc1 lds
    s_waitcnt vmcnt(40)
    v_mov_b32 v6, 1
    ds_write_b32 v3, v6 offset:108
    s_mov_b32 m0, 0x12000
    s_mov_b32 s60, 0x12000
    buffer_load_dwordx4 v4, s[40:43], s60 offen offset:0 sc1 lds
    buffer_load_dwordx4 v4, s[40:43], s60 offen offset:1024 sc1 lds
    buffer_load_dwordx4 v4, s[40:43], s60 offen offset:2048 sc1 lds
    buffer_load_dwordx4 v4, s[40:43], s60 offen offset:3072 sc1 lds
    s_mov_b32 m0, 0x13000
    s_mov_b32 s60, 0x13000
    buffer_load_dwordx4 v4, s[40:43], s60 offen offset:0 sc1 lds
    buffer_load_dwordx4 v4, s[40:43], s60 offen offset:1024 sc1 lds
    buffer_load_dwordx4 v4, s[40:43], s60 offen offset:2048 sc1 lds
    buffer_load_dwordx4 v4, s[40:43], s60 offen offset:3072 sc1 lds
    s_mov_b32 m0, 0x14000
    s_mov_b32 s60, 0x14000
    buffer_load_dwordx4 v4, s[40:43], s60 offen offset:0 sc1 lds
    buffer_load_dwordx4 v4, s[40:43], s60 offen offset:1024 sc1 lds
    buffer_load_dwordx4 v4, s[40:43], s60 offen offset:2048 sc1 lds
    buffer_load_dwordx4 v4, s[40:43], s60 offen offset:3072 sc1 lds
    s_mov_b32 m0, 0x15000
    s_mov_b32 s60, 0x15000
    buffer_load_dwordx4 v4, s[40:43], s60 offen offset:0 sc1 lds
    buffer_load_dwordx4 v4, s[40:43], s60 offen offset:1024 sc1 lds
    buffer_load_dwordx4 v4, s[40:43], s60 offen offset:2048 sc1 lds
    buffer_load_dwordx4 v4, s[40:43], s60 offen offset:3072 sc1 lds
    s_mul_i32 s60, s8, 4096
    s_add_u32 s44, s4, 0x12f6000
    s_addc_u32 s45, s5, 0
    s_add_u32 s44, s44, s60
    s_addc_u32 s45, s45, 0
    s_mov_b32 s46, 0x1000
    s_mov_b32 s47, 0x20000
    s_and_b32 s91, s9, 7
    v_lshrrev_b32 v8, 4, v1
    v_bfe_u32 v9, v1, 2, 2
    v_lshl_add_u32 v8, v8, 2, v9
    v_lshlrev_b32 v8, 6, v8
    v_lshl_add_u32 v8, v13, 3, v8
    s_lshr_b32 s60, s91, 1
    s_lshl_b32 s60, s60, 15
    s_and_b32 s61, s91, 1
    s_lshl_b32 s61, s61, 5
    s_add_u32 s60, s60, s61
    v_add_u32 v8, s60, v8
    s_waitcnt vmcnt(24)
    v_mov_b32 v6, 2
    ds_write_b32 v3, v6 offset:108
    s_cmp_lt_u32 s91, 4
    s_cbranch_scc1 Lcq_117
    s_mov_b32 m0, 0x16000
    s_mov_b32 s60, 0x16000
    buffer_load_dwordx4 v4, s[40:43], s60 offen offset:0 sc1 lds
    buffer_load_dwordx4 v4, s[40:43], s60 offen offset:1024 sc1 lds
    buffer_load_dwordx4 v4, s[40:43], s60 offen offset:2048 sc1 lds
    buffer_load_dwordx4 v4, s[40:43], s60 offen offset:3072 sc1 lds
    s_mov_b32 m0, 0x17000
    s_mov_b32 s60, 0x17000
    buffer_load_dwordx4 v4, s[40:43], s60 offen offset:0 sc1 lds
    buffer_load_dwordx4 v4, s[40:43], s60 offen offset:1024 sc1 lds
    buffer_load_dwordx4 v4, s[40:43], s60 offen offset:2048 sc1 lds
    buffer_load_dwordx4 v4, s[40:43], s60 offen offset:3072 sc1 lds
    s_mov_b32 m0, 0x18000
    s_mov_b32 s60, 0x18000
    buffer_load_dwordx4 v4, s[40:43], s60 offen offset:0 sc1 lds
    buffer_load_dwordx4 v4, s[40:43], s60 offen offset:1024 sc1 lds
    buffer_load_dwordx4 v4, s[40:43], s60 offen offset:2048 sc1 lds
    buffer_load_dwordx4 v4, s[40:43], s60 offen offset:3072 sc1 lds
    s_mov_b32 m0, 0x19000
    s_mov_b32 s60, 0x19000
    buffer_load_dwordx4 v4, s[40:43], s60 offen offset:0 sc1 lds
    buffer_load_dwordx4 v4, s[40:43], s60 offen offset:1024 sc1 lds
    buffer_load_dwordx4 v4, s[40:43], s60 offen offset:2048 sc1 lds
    buffer_load_dwordx4 v4, s[40:43], s60 offen offset:3072 sc1 lds
    s_mov_b32 m0, 0x1a000
    s_mov_b32 s60, 0x1a000
    buffer_load_dwordx4 v4, s[40:43], s60 offen offset:0 sc1 lds
    buffer_load_dwordx4 v4, s[40:43], s60 offen offset:1024 sc1 lds
    buffer_load_dwordx4 v4, s[40:43], s60 offen offset:2048 sc1 lds
    buffer_load_dwordx4 v4, s[40:43], s60 offen offset:3072 sc1 lds
    s_mov_b32 m0, 0x1b000
    s_mov_b32 s60, 0x1b000
    buffer_load_dwordx4 v4, s[40:43], s60 offen offset:0 sc1 lds
    buffer_load_dwordx4 v4, s[40:43], s60 offen offset:1024 sc1 lds
    buffer_load_dwordx4 v4, s[40:43], s60 offen offset:2048 sc1 lds
    buffer_load_dwordx4 v4, s[40:43], s60 offen offset:3072 sc1 lds
    s_mov_b32 m0, 0x1c000
    s_mov_b32 s60, 0x1c000
    buffer_load_dwordx4 v4, s[40:43], s60 offen offset:0 sc1 lds
    buffer_load_dwordx4 v4, s[40:43], s60 offen offset:1024 sc1 lds
    buffer_load_dwordx4 v4, s[40:43], s60 offen offset:2048 sc1 lds
    buffer_load_dwordx4 v4, s[40:43], s60 offen offset:3072 sc1 lds
    s_mov_b32 m0, 0x1d000
    s_mov_b32 s60, 0x1d000
    buffer_load_dwordx4 v4, s[40:43], s60 offen offset:0 sc1 lds
    buffer_load_dwordx4 v4, s[40:43], s60 offen offset:1024 sc1 lds
    buffer_load_dwordx4 v4, s[40:43], s60 offen offset:2048 sc1 lds
    buffer_load_dwordx4 v4, s[40:43], s60 offen offset:3072 sc1 lds
    s_mov_b32 m0, 0x1e000
    s_mov_b32 s60, 0x1e000
    buffer_load_dwordx4 v4, s[40:43], s60 offen offset:0 sc1 lds
    buffer_load_dwordx4 v4, s[40:43], s60 offen offset:1024 sc1 lds
    buffer_load_dwordx4 v4, s[40:43], s60 offen offset:2048 sc1 lds
    buffer_load_dwordx4 v4, s[40:43], s60 offen offset:3072 sc1 lds
    s_mov_b32 m0, 0x1f000
    s_mov_b32 s60, 0x1f000
    buffer_load_dwordx4 v4, s[40:43], s60 offen offset:0 sc1 lds
    buffer_load_dwordx4 v4, s[40:43], s60 offen offset:1024 sc1 lds
    buffer_load_dwordx4 v4, s[40:43], s60 offen offset:2048 sc1 lds
    buffer_load_dwordx4 v4, s[40:43], s60 offen offset:3072 sc1 lds
    s_waitcnt vmcnt(32)
    v_mov_b32 v6, 3
    ds_write_b32 v3, v6 offset:108
    s_waitcnt vmcnt(0)
    v_mov_b32 v6, 4
    ds_write_b32 v3, v6 offset:108
Lcq_117:
    ds_read_b64_tr_b16 v[32:33], v8 offset:0
    ds_read_b64_tr_b16 v[34:35], v8 offset:1024
    ds_read_b64_tr_b16 v[36:37], v8 offset:2048
    ds_read_b64_tr_b16 v[38:39], v8 offset:3072
    ds_read_b64_tr_b16 v[40:41], v8 offset:4096
    ds_read_b64_tr_b16 v[42:43], v8 offset:5120
    ds_read_b64_tr_b16 v[44:45], v8 offset:6144
    ds_read_b64_tr_b16 v[46:47], v8 offset:7168
    s_waitcnt lgkmcnt(7)
    v_mfma_f32_4x4x4_16b_bf16 v[16:19], v[32:33], v[32:33], 0
    v_mfma_f32_4x4x4_16b_bf16 v[20:23], v[68:69], v[32:33], 0
    s_waitcnt lgkmcnt(6)
    v_mfma_f32_4x4x4_16b_bf16 v[24:27], v[34:35], v[34:35], 0
    v_mfma_f32_4x4x4_16b_bf16 v[28:31], v[68:69], v[34:35], 0
    ds_read_b64_tr_b16 v[48:49], v8 offset:8192
    ds_read_b64_tr_b16 v[50:51], v8 offset:9216
    s_waitcnt lgkmcnt(7)
    v_mfma_f32_4x4x4_16b_bf16 v[16:19], v[36:37], v[36:37], v[16:19]
    v_mfma_f32_4x4x4_16b_bf16 v[20:23], v[68:69], v[36:37], v[20:23]
    s_waitcnt lgkmcnt(6)
    v_mfma_f32_4x4x4_16b_bf16 v[24:27], v[38:39], v[38:39], v[24:27]
    v_mfma_f32_4x4x4_16b_bf16 v[28:31], v[68:69], v[38:39], v[28:31]
    ds_read_b64_tr_b16 v[32:33], v8 offset:10240
    ds_read_b64_tr_b16 v[34:35], v8 offset:11264
    s_waitcnt lgkmcnt(7)
    v_mfma_f32_4x4x4_16b_bf16 v[16:19], v[40:41], v[40:41], v[16:19]
    v_mfma_f32_4x4x4_16b_bf16 v[20:23], v[68:69], v[40:41], v[20:23]
    s_waitcnt lgkmcnt(6)
    v_mfma_f32_4x4x4_16b_bf16 v[24:27], v[42:43], v[42:43], v[24:27]
    v_mfma_f32_4x4x4_16b_bf16 v[28:31], v[68:69], v[42:43], v[28:31]
    ds_read_b64_tr_b16 v[36:37], v8 offset:12288
    ds_read_b64_tr_b16 v[38:39], v8 offset:13312
    s_waitcnt lgkmcnt(7)
    v_mfma_f32_4x4x4_16b_bf16 v[16:19], v[44:45], v[44:45], v[16:19]
    v_mfma_f32_4x4x4_16b_bf16 v[20:23], v[68:69], v[44:45], v[20:23]
    s_waitcnt lgkmcnt(6)
    v_mfma_f32_4x4x4_16b_bf16 v[24:27], v[46:47], v[46:47], v[24:27]
    v_mfma_f32_4x4x4_16b_bf16 v[28:31], v[68:69], v[46:47], v[28:31]
    ds_read_b64_tr_b16 v[40:41], v8 offset:14336
    ds_read_b64_tr_b16 v[42:43], v8 offset:15360
    s_waitcnt lgkmcnt(7)
    v_mfma_f32_4x4x4_16b_bf16 v[16:19], v[48:49], v[48:49], v[16:19]
    v_mfma_f32_4x4x4_16b_bf16 v[20:23], v[68:69], v[48:49], v[20:23]
    s_waitcnt lgkmcnt(6)
    v_mfma_f32_4x4x4_16b_bf16 v[24:27], v[50:51], v[50:51], v[24:27]
    v_mfma_f32_4x4x4_16b_bf16 v[28:31], v[68:69], v[50:51], v[28:31]
    ds_read_b64_tr_b16 v[44:45], v8 offset:16384
    ds_read_b64_tr_b16 v[46:47], v8 offset:17408
    s_waitcnt lgkmcnt(7)
    v_mfma_f32_4x4x4_16b_bf16 v[16:19], v[32:33], v[32:33], v[16:19]
    v_mfma_f32_4x4x4_16b_bf16 v[20:23], v[68:69], v[32:33], v[20:23]
    s_waitcnt lgkmcnt(6)
    v_mfma_f32_4x4x4_16b_bf16 v[24:27], v[34:35], v[34:35], v[24:27]
    v_mfma_f32_4x4x4_16b_bf16 v[28:31], v[68:69], v[34:35], v[28:31]
    ds_read_b64_tr_b16 v[48:49], v8 offset:18432
    ds_read_b64_tr_b16 v[50:51], v8 offset:19456
    s_waitcnt lgkmcnt(7)
    v_mfma_f32_4x4x4_16b_bf16 v[16:19], v[36:37], v[36:37], v[16:19]
    v_mfma_f32_4x4x4_16b_bf16 v[20:23], v[68:69], v[36:37], v[20:23]
    s_waitcnt lgkmcnt(6)
    v_mfma_f32_4x4x4_16b_bf16 v[24:27], v[38:39], v[38:39], v[24:27]
    v_mfma_f32_4x4x4_16b_bf16 v[28:31], v[68:69], v[38:39], v[28:31]
    ds_read_b64_tr_b16 v[32:33], v8 offset:20480
    ds_read_b64_tr_b16 v[34:35], v8 offset:21504
    s_waitcnt lgkmcnt(7)
    v_mfma_f32_4x4x4_16b_bf16 v[16:19], v[40:41], v[40:41], v[16:19]
    v_mfma_f32_4x4x4_16b_bf16 v[20:23], v[68:69], v[40:41], v[20:23]
    s_waitcnt lgkmcnt(6)
    v_mfma_f32_4x4x4_16b_bf16 v[24:27], v[42:43], v[42:43], v[24:27]
    v_mfma_f32_4x4x4_16b_bf16 v[28:31], v[68:69], v[42:43], v[28:31]
    ds_read_b64_tr_b16 v[36:37], v8 offset:22528
    ds_read_b64_tr_b16 v[38:39], v8 offset:23552
    s_waitcnt lgkmcnt(7)
    v_mfma_f32_4x4x4_16b_bf16 v[16:19], v[44:45], v[44:45], v[16:19]
    v_mfma_f32_4x4x4_16b_bf16 v[20:23], v[68:69], v[44:45], v[20:23]
    s_waitcnt lgkmcnt(6)
    v_mfma_f32_4x4x4_16b_bf16 v[24:27], v[46:47], v[46:47], v[24:27]
    v_mfma_f32_4x4x4_16b_bf16 v[28:31], v[68:69], v[46:47], v[28:31]
    ds_read_b64_tr_b16 v[40:41], v8 offset:24576
    ds_read_b64_tr_b16 v[42:43], v8 offset:25600
    s_waitcnt lgkmcnt(7)
    v_mfma_f32_4x4x4_16b_bf16 v[16:19], v[48:49], v[48:49], v[16:19]
    v_mfma_f32_4x4x4_16b_bf16 v[20:23], v[68:69], v[48:49], v[20:23]
    s_waitcnt lgkmcnt(6)
    v_mfma_f32_4x4x4_16b_bf16 v[24:27], v[50:51], v[50:51], v[24:27]
    v_mfma_f32_4x4x4_16b_bf16 v[28:31], v[68:69], v[50:51], v[28:31]
    ds_read_b64_tr_b16 v[44:45], v8 offset:26624
    ds_read_b64_tr_b16 v[46:47], v8 offset:27648
    s_waitcnt lgkmcnt(7)
    v_mfma_f32_4x4x4_16b_bf16 v[16:19], v[32:33], v[32:33], v[16:19]
    v_mfma_f32_4x4x4_16b_bf16 v[20:23], v[68:69], v[32:33], v[20:23]
    s_waitcnt lgkmcnt(6)
    v_mfma_f32_4x4x4_16b_bf16 v[24:27], v[34:35], v[34:35], v[24:27]
    v_mfma_f32_4x4x4_16b_bf16 v[28:31], v[68:69], v[34:35], v[28:31]
    ds_read_b64_tr_b16 v[48:49], v8 offset:28672
    ds_read_b64_tr_b16 v[50:51], v8 offset:29696
    s_waitcnt lgkmcnt(7)
    v_mfma_f32_4x4x4_16b_bf16 v[16:19], v[36:37], v[36:37], v[16:19]
    v_mfma_f32_4x4x4_16b_bf16 v[20:23], v[68:69], v[36:37], v[20:23]
    s_waitcnt lgkmcnt(6)
    v_mfma_f32_4x4x4_16b_bf16 v[24:27], v[38:39], v[38:39], v[24:27]
    v_mfma_f32_4x4x4_16b_bf16 v[28:31], v[68:69], v[38:39], v[28:31]
    ds_read_b64_tr_b16 v[32:33], v8 offset:30720
    ds_read_b64_tr_b16 v[34:35], v8 offset:31744
    s_waitcnt lgkmcnt(7)
    v_mfma_f32_4x4x4_16b_bf16 v[16:19], v[40:41], v[40:41], v[16:19]
    v_mfma_f32_4x4x4_16b_bf16 v[20:23], v[68:69], v[40:41], v[20:23]
    s_waitcnt lgkmcnt(6)
    v_mfma_f32_4x4x4_16b_bf16 v[24:27], v[42:43], v[42:43], v[24:27]
    v_mfma_f32_4x4x4_16b_bf16 v[28:31], v[68:69], v[42:43], v[28:31]
    s_waitcnt lgkmcnt(5)
    v_mfma_f32_4x4x4_16b_bf16 v[16:19], v[44:45], v[44:45], v[16:19]
    v_mfma_f32_4x4x4_16b_bf16 v[20:23], v[68:69], v[44:45], v[20:23]
    s_waitcnt lgkmcnt(4)
    v_mfma_f32_4x4x4_16b_bf16 v[24:27], v[46:47], v[46:47], v[24:27]
    v_mfma_f32_4x4x4_16b_bf16 v[28:31], v[68:69], v[46:47], v[28:31]
    s_waitcnt lgkmcnt(3)
    v_mfma_f32_4x4x4_16b_bf16 v[16:19], v[48:49], v[48:49], v[16:19]
    v_mfma_f32_4x4x4_16b_bf16 v[20:23], v[68:69], v[48:49], v[20:23]
    s_waitcnt lgkmcnt(2)
    v_mfma_f32_4x4x4_16b_bf16 v[24:27], v[50:51], v[50:51], v[24:27]
    v_mfma_f32_4x4x4_16b_bf16 v[28:31], v[68:69], v[50:51], v[28:31]
    s_waitcnt lgkmcnt(1)
    v_mfma_f32_4x4x4_16b_bf16 v[16:19], v[32:33], v[32:33], v[16:19]
    v_mfma_f32_4x4x4_16b_bf16 v[20:23], v[68:69], v[32:33], v[20:23]
    s_waitcnt lgkmcnt(0)
    v_mfma_f32_4x4x4_16b_bf16 v[24:27], v[34:35], v[34:35], v[24:27]
    v_mfma_f32_4x4x4_16b_bf16 v[28:31], v[68:69], v[34:35], v[28:31]
    s_mov_b32 s61, 0x05040100
    s_mov_b32 s62, 0x07060302
    s_nop 3
    v_add_f32 v72, v20, v28
    v_add_f32 v16, v16, v24
    v_add_f32 v17, v17, v25
    v_add_f32 v18, v18, v26
    v_add_f32 v19, v19, v27
    v_mov_b32 v74, v72
    v_cndmask_b32 v73, v16, v17, s[74:75]
    v_cndmask_b32 v75, v18, v19, s[78:79]
    v_permlane32_swap_b32 v72, v74
    s_or_b64 vcc, s[76:77], s[78:79]
    v_cndmask_b32 v73, v73, v75, vcc
    v_add_f32 v72, v72, v74
    v_mov_b32 v75, v73
    v_mov_b32 v74, v72
    s_nop 0
    v_permlane32_swap_b32 v73, v75
    v_permlane16_swap_b32 v72, v74
    v_add_f32 v73, v73, v75
    v_add_f32 v72, v72, v74
    v_mov_b32 v75, v73
    s_nop 1
    v_permlane16_swap_b32 v73, v75
    v_add_f32 v73, v73, v75
    v_mul_f32 v72, 0xbb000000, v72
    v_mov_b32 v207, s100
    v_mov_b32 v203, s100
    v_mul_f32 v74, v72, v72
    v_fma_f32 v73, v73, s89, -v74
    v_max_f32 v73, 0, v73
    v_add_f32 v206, 0x3727c5ac, v73
    v_rsq_f32 v208, v206
    s_nop 0
    v_mul_f32 v73, v206, v208
    v_mul_f32 v209, v208, v208
    v_cvt_pk_bf16_f32 v201, v72, v73
    v_mul_f32 v204, 0xc0135761, v208
    v_mul_f32 v209, v209, v208
    v_lshlrev_b32 v212, 16, v201
    v_and_b32 v213, s10, v201
    v_mul_f32 v205, 0xbdd2d3e8, v209
    v_sub_f32 v72, v72, v212
    v_sub_f32 v73, v73, v213
    v_cvt_pk_bf16_f32 v211, v72, v73
    v_perm_b32 v200, v211, v201, s61
    v_perm_b32 v202, v201, v211, s62
    v_cmp_gt_u32 vcc, 16, v1
    s_nop 1
    v_cndmask_b32 v200, v204, v200, vcc
    v_cndmask_b32 v201, v205, v201, vcc
    v_cndmask_b32 v202, v206, v202, vcc
    v_cndmask_b32 v203, v207, v203, vcc
    s_lshl_b32 s60, s91, 9
    s_mov_b32 exec_hi, 0
    buffer_store_dwordx4 v[200:203], v4, s[44:47], s60 offen sc1
    s_mov_b64 exec, -1
    s_cmp_ge_u32 s91, 4
    s_cbranch_scc1 Lcq_118
    s_mov_b32 m0, 0x16000
    s_mov_b32 s60, 0x16000
    buffer_load_dwordx4 v4, s[40:43], s60 offen offset:0 sc1 lds
    buffer_load_dwordx4 v4, s[40:43], s60 offen offset:1024 sc1 lds
    buffer_load_dwordx4 v4, s[40:43], s60 offen offset:2048 sc1 lds
    buffer_load_dwordx4 v4, s[40:43], s60 offen offset:3072 sc1 lds
    s_mov_b32 m0, 0x17000
    s_mov_b32 s60, 0x17000
    buffer_load_dwordx4 v4, s[40:43], s60 offen offset:0 sc1 lds
    buffer_load_dwordx4 v4, s[40:43], s60 offen offset:1024 sc1 lds
    buffer_load_dwordx4 v4, s[40:43], s60 offen offset:2048 sc1 lds
    buffer_load_dwordx4 v4, s[40:43], s60 offen offset:3072 sc1 lds
    s_mov_b32 m0, 0x18000
    s_mov_b32 s60, 0x18000
    buffer_load_dwordx4 v4, s[40:43], s60 offen offset:0 sc1 lds
    buffer_load_dwordx4 v4, s[40:43], s60 offen offset:1024 sc1 lds
    buffer_load_dwordx4 v4, s[40:43], s60 offen offset:2048 sc1 lds
    buffer_load_dwordx4 v4, s[40:43], s60 offen offset:3072 sc1 lds
    s_mov_b32 m0, 0x19000
    s_mov_b32 s60, 0x19000
    buffer_load_dwordx4 v4, s[40:43], s60 offen offset:0 sc1 lds
    buffer_load_dwordx4 v4, s[40:43], s60 offen offset:1024 sc1 lds
    buffer_load_dwordx4 v4, s[40:43], s60 offen offset:2048 sc1 lds
    buffer_load_dwordx4 v4, s[40:43], s60 offen offset:3072 sc1 lds
    s_mov_b32 m0, 0x1a000
    s_mov_b32 s60, 0x1a000
    buffer_load_dwordx4 v4, s[40:43], s60 offen offset:0 sc1 lds
    buffer_load_dwordx4 v4, s[40:43], s60 offen offset:1024 sc1 lds
    buffer_load_dwordx4 v4, s[40:43], s60 offen offset:2048 sc1 lds
    buffer_load_dwordx4 v4, s[40:43], s60 offen offset:3072 sc1 lds
    s_mov_b32 m0, 0x1b000
    s_mov_b32 s60, 0x1b000
    buffer_load_dwordx4 v4, s[40:43], s60 offen offset:0 sc1 lds
    buffer_load_dwordx4 v4, s[40:43], s60 offen offset:1024 sc1 lds
    buffer_load_dwordx4 v4, s[40:43], s60 offen offset:2048 sc1 lds
    buffer_load_dwordx4 v4, s[40:43], s60 offen offset:3072 sc1 lds
    s_mov_b32 m0, 0x1c000
    s_mov_b32 s60, 0x1c000
    buffer_load_dwordx4 v4, s[40:43], s60 offen offset:0 sc1 lds
    buffer_load_dwordx4 v4, s[40:43], s60 offen offset:1024 sc1 lds
    buffer_load_dwordx4 v4, s[40:43], s60 offen offset:2048 sc1 lds
    buffer_load_dwordx4 v4, s[40:43], s60 offen offset:3072 sc1 lds
    s_mov_b32 m0, 0x1d000
    s_mov_b32 s60, 0x1d000
    buffer_load_dwordx4 v4, s[40:43], s60 offen offset:0 sc1 lds
    buffer_load_dwordx4 v4, s[40:43], s60 offen offset:1024 sc1 lds
    buffer_load_dwordx4 v4, s[40:43], s60 offen offset:2048 sc1 lds
    buffer_load_dwordx4 v4, s[40:43], s60 offen offset:3072 sc1 lds
    s_mov_b32 m0, 0x1e000
    s_mov_b32 s60, 0x1e000
    buffer_load_dwordx4 v4, s[40:43], s60 offen offset:0 sc1 lds
    buffer_load_dwordx4 v4, s[40:43], s60 offen offset:1024 sc1 lds
    buffer_load_dwordx4 v4, s[40:43], s60 offen offset:2048 sc1 lds
    buffer_load_dwordx4 v4, s[40:43], s60 offen offset:3072 sc1 lds
    s_mov_b32 m0, 0x1f000
    s_mov_b32 s60, 0x1f000
    buffer_load_dwordx4 v4, s[40:43], s60 offen offset:0 sc1 lds
    buffer_load_dwordx4 v4, s[40:43], s60 offen offset:1024 sc1 lds
    buffer_load_dwordx4 v4, s[40:43], s60 offen offset:2048 sc1 lds
    buffer_load_dwordx4 v4, s[40:43], s60 offen offset:3072 sc1 lds
    s_waitcnt vmcnt(32)
    v_mov_b32 v6, 3
    ds_write_b32 v3, v6 offset:108
    s_waitcnt vmcnt(0)
    v_mov_b32 v6, 4
    ds_write_b32 v3, v6 offset:108
Lcq_118:
    v_bfe_u32 v8, v1, 4, 1
    v_cmp_eq_u32 s[74:75], 0, v8
    v_mul_u32_u24 v8, 2048, v8
    v_lshrrev_b32 v9, 5, v1
    v_lshl_add_u32 v8, v9, 8, v8
    v_and_b32 v9, 15, v1
    v_lshl_add_u32 v8, v9, 4, v8
    v_add_u32 v8, v8, v3
    s_mov_b32 s11, 0
Lcs_119:
    buffer_load_dwordx4 v[72:75], v4, s[44:47], 0 offen offset:0 sc1
    buffer_load_dwordx4 v[76:79], v4, s[44:47], 0 offen offset:1024 sc1
    s_add_u32 s11, s11, 1
    s_waitcnt vmcnt(0)
    s_cmp_gt_u32 s11, 1000000
    s_cbranch_scc1 Lcd_120
    v_cmp_ne_u32 vcc, s100, v75
    v_cmp_ne_u32 s[76:77], s100, v79
    s_or_b64 vcc, vcc, s[76:77]
    s_cbranch_scc1 Lcs_119
Lcd_120:
    v_mov_b32 v75, 0
    v_mov_b32 v79, 0
    ds_write_b128 v8, v[72:75] offset:512
    ds_write_b128 v8, v[76:79] offset:1024
    v_mov_b32 v6, 2
    ds_write_b32 v3, v6 offset:48
    s_mov_b32 s11, 0
Lcs_121:
    buffer_load_dwordx4 v[72:75], v4, s[44:47], 0 offen offset:2048 sc1
    buffer_load_dwordx4 v[76:79], v4, s[44:47], 0 offen offset:3072 sc1
    s_add_u32 s11, s11, 1
    s_waitcnt vmcnt(0)
    s_cmp_gt_u32 s11, 1000000
    s_cbranch_scc1 Lcd_122
    v_cmp_ne_u32 vcc, s100, v75
    v_cmp_ne_u32 s[76:77], s100, v79
    s_or_b64 vcc, vcc, s[76:77]
    s_cbranch_scc1 Lcs_121
Lcd_122:
    v_mov_b32 v75, 0
    v_mov_b32 v79, 0
    ds_write_b128 v8, v[72:75] offset:1536
    ds_write_b128 v8, v[76:79] offset:2048
    v_mov_b32 v6, 4
    ds_write_b32 v3, v6 offset:48
    s_mul_i32 s60, s71, 229376
    s_add_u32 s44, s4, 0xa1c000
    s_addc_u32 s45, s5, 0
    s_add_u32 s44, s44, s60
    s_addc_u32 s45, s45, 0
    s_mov_b32 s46, 0x38000
    s_mov_b32 s47, 0x20000
    s_mov_b32 s66, 0
Lsp_123:
    ds_read_b32 v6, v3 offset:120
    s_add_u32 s66, s66, 1
    s_cmp_gt_u32 s66, 8000000
    s_waitcnt lgkmcnt(0)
    s_cbranch_scc1 Lsd_124
    v_readfirstlane_b32 s11, v6
    s_cmp_ge_u32 s11, 7
    s_cbranch_scc0 Lsp_123
Lsd_124:
    s_setprio 0
    s_mov_b32 m0, 0x0
    s_mov_b32 s60, 0x2800
    buffer_load_dwordx4 v4, s[44:47], s60 offen offset:0 sc1 lds
    buffer_load_dwordx4 v4, s[44:47], s60 offen offset:1024 sc1 lds
    buffer_load_dwordx4 v4, s[44:47], s60 offen offset:2048 sc1 lds
    buffer_load_dwordx4 v4, s[44:47], s60 offen offset:3072 sc1 lds
    s_mov_b32 m0, 0x1000
    s_mov_b32 s60, 0x3800
    buffer_load_dwordx4 v4, s[44:47], s60 offen offset:0 sc1 lds
    buffer_load_dwordx4 v4, s[44:47], s60 offen offset:1024 sc1 lds
    buffer_load_dwordx4 v4, s[44:47], s60 offen offset:2048 sc1 lds
    buffer_load_dwordx4 v4, s[44:47], s60 offen offset:3072 sc1 lds
    s_mov_b32 m0, 0x2000
    s_mov_b32 s60, 0x4800
    buffer_load_dwordx4 v4, s[44:47], s60 offen offset:0 sc1 lds
    s_mov_b32 m0, 0x2400
    s_mov_b32 s60, 0xa800
    buffer_load_dwordx4 v4, s[44:47], s60 offen offset:0 sc1 lds
    buffer_load_dwordx4 v4, s[44:47], s60 offen offset:1024 sc1 lds
    buffer_load_dwordx4 v4, s[44:47], s60 offen offset:2048 sc1 lds
    buffer_load_dwordx4 v4, s[44:47], s60 offen offset:3072 sc1 lds
    s_mov_b32 m0, 0x3400
    s_mov_b32 s60, 0xb800
    buffer_load_dwordx4 v4, s[44:47], s60 offen offset:0 sc1 lds
    buffer_load_dwordx4 v4, s[44:47], s60 offen offset:1024 sc1 lds
    buffer_load_dwordx4 v4, s[44:47], s60 offen offset:2048 sc1 lds
    buffer_load_dwordx4 v4, s[44:47], s60 offen offset:3072 sc1 lds
    s_mov_b32 m0, 0x4400
    s_mov_b32 s60, 0xc800
    buffer_load_dwordx4 v4, s[44:47], s60 offen offset:0 sc1 lds
    s_mov_b32 m0, 0x4800
    s_mov_b32 s60, 0x12800
    buffer_load_dwordx4 v4, s[44:47], s60 offen offset:0 sc1 lds
    buffer_load_dwordx4 v4, s[44:47], s60 offen offset:1024 sc1 lds
    buffer_load_dwordx4 v4, s[44:47], s60 offen offset:2048 sc1 lds
    buffer_load_dwordx4 v4, s[44:47], s60 offen offset:3072 sc1 lds
    s_mov_b32 m0, 0x5800
    s_mov_b32 s60, 0x13800
    buffer_load_dwordx4 v4, s[44:47], s60 offen offset:0 sc1 lds
    buffer_load_dwordx4 v4, s[44:47], s60 offen offset:1024 sc1 lds
    buffer_load_dwordx4 v4, s[44:47], s60 offen offset:2048 sc1 lds
    buffer_load_dwordx4 v4, s[44:47], s60 offen offset:3072 sc1 lds
    s_mov_b32 m0, 0x6800
    s_mov_b32 s60, 0x14800
    buffer_load_dwordx4 v4, s[44:47], s60 offen offset:0 sc1 lds
    s_mov_b32 m0, 0x6c00
    s_mov_b32 s60, 0x1a800
    buffer_load_dwordx4 v4, s[44:47], s60 offen offset:0 sc1 lds
    buffer_load_dwordx4 v4, s[44:47], s60 offen offset:1024 sc1 lds
    buffer_load_dwordx4 v4, s[44:47], s60 offen offset:2048 sc1 lds
    buffer_load_dwordx4 v4, s[44:47], s60 offen offset:3072 sc1 lds
    s_mov_b32 m0, 0x7c00
    s_mov_b32 s60, 0x1b800
    buffer_load_dwordx4 v4, s[44:47], s60 offen offset:0 sc1 lds
    buffer_load_dwordx4 v4, s[44:47], s60 offen offset:1024 sc1 lds
    buffer_load_dwordx4 v4, s[44:47], s60 offen offset:2048 sc1 lds
    buffer_load_dwordx4 v4, s[44:47], s60 offen offset:3072 sc1 lds
    s_mov_b32 m0, 0x8c00
    s_mov_b32 s60, 0x1c800
    buffer_load_dwordx4 v4, s[44:47], s60 offen offset:0 sc1 lds
    s_mov_b32 m0, 0x9000
    s_mov_b32 s60, 0x22800
    buffer_load_dwordx4 v4, s[44:47], s60 offen offset:0 sc1 lds
    buffer_load_dwordx4 v4, s[44:47], s60 offen offset:1024 sc1 lds
    buffer_load_dwordx4 v4, s[44:47], s60 offen offset:2048 sc1 lds
    buffer_load_dwordx4 v4, s[44:47], s60 offen offset:3072 sc1 lds
    s_mov_b32 m0, 0xa000
    s_mov_b32 s60, 0x23800
    buffer_load_dwordx4 v4, s[44:47], s60 offen offset:0 sc1 lds
    buffer_load_dwordx4 v4, s[44:47], s60 offen offset:1024 sc1 lds
    buffer_load_dwordx4 v4, s[44:47], s60 offen offset:2048 sc1 lds
    buffer_load_dwordx4 v4, s[44:47], s60 offen offset:3072 sc1 lds
    s_mov_b32 m0, 0xb000
    s_mov_b32 s60, 0x24800
    buffer_load_dwordx4 v4, s[44:47], s60 offen offset:0 sc1 lds
    s_mov_b32 m0, 0xb400
    s_mov_b32 s60, 0x2a800
    buffer_load_dwordx4 v4, s[44:47], s60 offen offset:0 sc1 lds
    buffer_load_dwordx4 v4, s[44:47], s60 offen offset:1024 sc1 lds
    buffer_load_dwordx4 v4, s[44:47], s60 offen offset:2048 sc1 lds
    buffer_load_dwordx4 v4, s[44:47], s60 offen offset:3072 sc1 lds
    s_mov_b32 m0, 0xc400
    s_mov_b32 s60, 0x2b800
    buffer_load_dwordx4 v4, s[44:47], s60 offen offset:0 sc1 lds
    buffer_load_dwordx4 v4, s[44:47], s60 offen offset:1024 sc1 lds
    buffer_load_dwordx4 v4, s[44:47], s60 offen offset:2048 sc1 lds
    buffer_load_dwordx4 v4, s[44:47], s60 offen offset:3072 sc1 lds
    s_mov_b32 m0, 0xd400
    s_mov_b32 s60, 0x2c800
    buffer_load_dwordx4 v4, s[44:47], s60 offen offset:0 sc1 lds
    s_mov_b32 m0, 0xd800
    s_mov_b32 s60, 0x32800
    buffer_load_dwordx4 v4, s[44:47], s60 offen offset:0 sc1 lds
    buffer_load_dwordx4 v4, s[44:47], s60 offen offset:1024 sc1 lds
    buffer_load_dwordx4 v4, s[44:47], s60 offen offset:2048 sc1 lds
    buffer_load_dwordx4 v4, s[44:47], s60 offen offset:3072 sc1 lds
    s_mov_b32 m0, 0xe800
    s_mov_b32 s60, 0x33800
    buffer_load_dwordx4 v4, s[44:47], s60 offen offset:0 sc1 lds
    buffer_load_dwordx4 v4, s[44:47], s60 offen offset:1024 sc1 lds
    buffer_load_dwordx4 v4, s[44:47], s60 offen offset:2048 sc1 lds
    buffer_load_dwordx4 v4, s[44:47], s60 offen offset:3072 sc1 lds
    s_mov_b32 m0, 0xf800
    s_mov_b32 s60, 0x34800
    buffer_load_dwordx4 v4, s[44:47], s60 offen offset:0 sc1 lds
    s_waitcnt vmcnt(0)
    v_mov_b32 v6, 1
    ds_write_b32 v3, v6 offset:124
    s_lshl_b32 s60, s8, 11
    s_and_b32 s61, s9, 3
    s_lshl_b32 s61, s61, 9
    s_add_u32 s60, s60, s61
    s_add_u32 s90, s60, 0x12e4000
    s_setprio 0
    s_cmp_lg_u32 s2, 0
    s_cbranch_scc1 Lep_125
    v_mov_b32 v7, 0x12dc000
    v_mov_b32 v6, s100
    s_mov_b64 exec, 1
    global_store_dword v7, v6, s[4:5] sc1
    s_mov_b64 exec, -1
Lep_125:
    s_add_u32 s62, s4, s90
    s_addc_u32 s63, s5, 0
    s_mov_b32 s11, 0
Lpo_126:
    s_add_u32 s11, s11, 1
    s_cmp_gt_u32 s11, 1000000
    s_cbranch_scc1 Lpd_128
    s_load_dwordx16 s[16:31], s[62:63], 0 glc
Lpc_127:
    s_waitcnt lgkmcnt(0)
    s_cmp_eq_u64 s[16:17], s[100:101]
    s_cbranch_scc0 Lpo_126
    s_cmp_eq_u64 s[18:19], s[100:101]
    s_cbranch_scc0 Lpo_126
    s_cmp_eq_u64 s[20:21], s[100:101]
    s_cbranch_scc0 Lpo_126
    s_cmp_eq_u64 s[22:23], s[100:101]
    s_cbranch_scc0 Lpo_126
    s_cmp_eq_u64 s[24:25], s[100:101]
    s_cbranch_scc0 Lpo_126
    s_cmp_eq_u64 s[26:27], s[100:101]
    s_cbranch_scc0 Lpo_126
    s_cmp_eq_u64 s[28:29], s[100:101]
    s_cbranch_scc0 Lpo_126
    s_cmp_eq_u64 s[30:31], s[100:101]
    s_cbranch_scc0 Lpo_126
Lpd_128:
    v_mov_b32 v6, 1
    ds_write_b32 v3, v6 offset:68
    s_mov_b32 s11, 0
Lpo_129:
    s_add_u32 s11, s11, 1
    s_cmp_gt_u32 s11, 1000000
    s_cbranch_scc1 Lpd_131
    s_load_dwordx16 s[16:31], s[62:63], 128 glc
Lpc_130:
    s_waitcnt lgkmcnt(0)
    s_cmp_eq_u64 s[16:17], s[100:101]
    s_cbranch_scc0 Lpo_129
    s_cmp_eq_u64 s[18:19], s[100:101]
    s_cbranch_scc0 Lpo_129
    s_cmp_eq_u64 s[20:21], s[100:101]
    s_cbranch_scc0 Lpo_129
    s_cmp_eq_u64 s[22:23], s[100:101]
    s_cbranch_scc0 Lpo_129
    s_cmp_eq_u64 s[24:25], s[100:101]
    s_cbranch_scc0 Lpo_129
    s_cmp_eq_u64 s[26:27], s[100:101]
    s_cbranch_scc0 Lpo_129
    s_cmp_eq_u64 s[28:29], s[100:101]
    s_cbranch_scc0 Lpo_129
    s_cmp_eq_u64 s[30:31], s[100:101]
    s_cbranch_scc0 Lpo_129
Lpd_131:
    v_mov_b32 v6, 2
    ds_write_b32 v3, v6 offset:68
    s_mov_b32 s11, 0
Lpo_132:
    s_add_u32 s11, s11, 1
    s_cmp_gt_u32 s11, 1000000
    s_cbranch_scc1 Lpd_134
    s_load_dwordx16 s[16:31], s[62:63], 256 glc
Lpc_133:
    s_waitcnt lgkmcnt(0)
    s_cmp_eq_u64 s[16:17], s[100:101]
    s_cbranch_scc0 Lpo_132
    s_cmp_eq_u64 s[18:19], s[100:101]
    s_cbranch_scc0 Lpo_132
    s_cmp_eq_u64 s[20:21], s[100:101]
    s_cbranch_scc0 Lpo_132
    s_cmp_eq_u64 s[22:23], s[100:101]
    s_cbranch_scc0 Lpo_132
    s_cmp_eq_u64 s[24:25], s[100:101]
    s_cbranch_scc0 Lpo_132
    s_cmp_eq_u64 s[26:27], s[100:101]
    s_cbranch_scc0 Lpo_132
    s_cmp_eq_u64 s[28:29], s[100:101]
    s_cbranch_scc0 Lpo_132
    s_cmp_eq_u64 s[30:31], s[100:101]
    s_cbranch_scc0 Lpo_132
Lpd_134:
    v_mov_b32 v6, 3
    ds_write_b32 v3, v6 offset:68
    s_mov_b32 s11, 0
Lpo_135:
    s_add_u32 s11, s11, 1
    s_cmp_gt_u32 s11, 1000000
    s_cbranch_scc1 Lpd_137
    s_load_dwordx16 s[16:31], s[62:63], 384 glc
Lpc_136:
    s_waitcnt lgkmcnt(0)
    s_cmp_eq_u64 s[16:17], s[100:101]
    s_cbranch_scc0 Lpo_135
    s_cmp_eq_u64 s[18:19], s[100:101]
    s_cbranch_scc0 Lpo_135
    s_cmp_eq_u64 s[20:21], s[100:101]
    s_cbranch_scc0 Lpo_135
    s_cmp_eq_u64 s[22:23], s[100:101]
    s_cbranch_scc0 Lpo_135
    s_cmp_eq_u64 s[24:25], s[100:101]
    s_cbranch_scc0 Lpo_135
    s_cmp_eq_u64 s[26:27], s[100:101]
    s_cbranch_scc0 Lpo_135
    s_cmp_eq_u64 s[28:29], s[100:101]
    s_cbranch_scc0 Lpo_135
    s_cmp_eq_u64 s[30:31], s[100:101]
    s_cbranch_scc0 Lpo_135
Lpd_137:
    v_mov_b32 v6, 4
    ds_write_b32 v3, v6 offset:68
    s_mov_b32 s44, s12
    s_mov_b32 s45, s13
    s_mov_b32 s46, 0x200000
    s_mov_b32 s47, 0x20000
    s_mov_b32 s66, 0
Lsp_138:
    ds_read_b32 v6, v3 offset:132
    s_add_u32 s66, s66, 1
    s_cmp_gt_u32 s66, 8000000
    s_waitcnt lgkmcnt(0)
    s_cbranch_scc1 Lsd_139
    v_readfirstlane_b32 s11, v6
    s_cmp_ge_u32 s11, 7
    s_cbranch_scc0 Lsp_138
Lsd_139:
    v_add_u32 v8, 0x8000, v125
    v_add_u32 v15, 0x21000, v125
    ds_read_b128 v[216:219], v8 offset:0
    ds_read_b128 v[220:223], v8 offset:4096
    ds_read_b128 v[224:227], v8 offset:8192
    ds_read_b128 v[228:231], v8 offset:12288
    ds_read_b128 v[232:235], v8 offset:16384
    ds_read_b128 v[236:239], v8 offset:20480
    ds_read2_b32 v[240:241], v127 offset0:64 offset1:66
    ds_read2_b32 v[242:243], v127 offset0:68 offset1:70
    ds_read_b128 v[244:247], v15
    s_waitcnt lgkmcnt(7)
    v_pk_add_f32 v[216:217], v[216:217], v[220:221]
    v_pk_add_f32 v[218:219], v[218:219], v[222:223]
    ds_read_b128 v[220:223], v8 offset:24576
    s_waitcnt lgkmcnt(6)
    v_pk_add_f32 v[224:225], v[224:225], v[228:229]
    v_pk_add_f32 v[226:227], v[226:227], v[230:231]
    s_waitcnt lgkmcnt(4)
    v_pk_add_f32 v[232:233], v[232:233], v[236:237]
    v_pk_add_f32 v[234:235], v[234:235], v[238:239]
    v_pk_add_f32 v[216:217], v[216:217], v[224:225]
    v_pk_add_f32 v[218:219], v[218:219], v[226:227]
    s_waitcnt lgkmcnt(0)
    v_pk_add_f32 v[232:233], v[232:233], v[220:221]
    v_pk_add_f32 v[234:235], v[234:235], v[222:223]
    v_pk_add_f32 v[216:217], v[216:217], v[232:233]
    v_pk_add_f32 v[218:219], v[218:219], v[234:235]
    v_pk_fma_f32 v[216:217], v[216:217], v[240:241], v[244:245]
    v_pk_fma_f32 v[218:219], v[218:219], v[242:243], v[246:247]
    s_nop 1
    v_permlane32_swap_b32 v216, v218
    v_permlane32_swap_b32 v217, v219
    v_cvt_pk_bf16_f32 v220, v216, v218
    v_cvt_pk_bf16_f32 v221, v217, v219
    s_add_u32 s60, s88, 32768
    buffer_store_dwordx2 v[220:221], v126, s[44:47], s60 offen
Lrd_140:
    s_branch L_fin
L_p4:
    s_mov_b32 s44, s12
    s_mov_b32 s45, s13
    s_mov_b32 s46, 0x200000
    s_mov_b32 s47, 0x20000
    v_mfma_f32_16x16x32_bf16 v[48:51], v[100:103], v[216:219], 0
    v_mfma_f32_16x16x32_bf16 v[52:55], v[104:107], v[216:219], 0
    v_mfma_f32_16x16x32_bf16 v[56:59], v[108:111], v[216:219], 0
    v_mfma_f32_16x16x32_bf16 v[60:63], v[112:115], v[216:219], 0
    v_mfma_f32_16x16x32_bf16 v[48:51], v[116:119], v[220:223], v[48:51]
    v_mfma_f32_16x16x32_bf16 v[52:55], v[120:123], v[220:223], v[52:55]
    v_mfma_f32_16x16x32_bf16 v[56:59], v[32:35], v[220:223], v[56:59]
    v_mfma_f32_16x16x32_bf16 v[60:63], v[36:39], v[220:223], v[60:63]
    v_mfma_f32_16x16x32_bf16 v[48:51], v[40:43], v[224:227], v[48:51]
    v_mfma_f32_16x16x32_bf16 v[52:55], v[44:47], v[224:227], v[52:55]
    v_mfma_f32_16x16x32_bf16 v[56:59], v[128:131], v[224:227], v[56:59]
    v_mfma_f32_16x16x32_bf16 v[60:63], v[132:135], v[224:227], v[60:63]
    v_mfma_f32_16x16x32_bf16 v[48:51], v[136:139], v[228:231], v[48:51]
    v_mfma_f32_16x16x32_bf16 v[52:55], v[140:143], v[228:231], v[52:55]
    v_mfma_f32_16x16x32_bf16 v[56:59], v[144:147], v[228:231], v[56:59]
    v_mfma_f32_16x16x32_bf16 v[60:63], v[148:151], v[228:231], v[60:63]
    v_mfma_f32_16x16x32_bf16 v[48:51], v[152:155], v[232:235], v[48:51]
    v_mfma_f32_16x16x32_bf16 v[52:55], v[156:159], v[232:235], v[52:55]
    v_mfma_f32_16x16x32_bf16 v[56:59], v[160:163], v[232:235], v[56:59]
    v_mfma_f32_16x16x32_bf16 v[60:63], v[164:167], v[232:235], v[60:63]
    v_mfma_f32_16x16x32_bf16 v[48:51], v[168:171], v[236:239], v[48:51]
    v_mfma_f32_16x16x32_bf16 v[52:55], v[172:175], v[236:239], v[52:55]
    v_mfma_f32_16x16x32_bf16 v[56:59], v[176:179], v[236:239], v[56:59]
    v_mfma_f32_16x16x32_bf16 v[60:63], v[180:183], v[236:239], v[60:63]
    v_mfma_f32_16x16x32_bf16 v[48:51], v[184:187], v[240:243], v[48:51]
    v_mfma_f32_16x16x32_bf16 v[52:55], v[188:191], v[240:243], v[52:55]
    v_mfma_f32_16x16x32_bf16 v[56:59], v[192:195], v[240:243], v[56:59]
    v_mfma_f32_16x16x32_bf16 v[60:63], v[196:199], v[240:243], v[60:63]
    v_mfma_f32_16x16x32_bf16 v[48:51], v[200:203], v[244:247], v[48:51]
    s_waitcnt vmcnt(10)
    v_mfma_f32_16x16x32_bf16 v[52:55], v[204:207], v[244:247], v[52:55]
    s_waitcnt vmcnt(9)
    v_mfma_f32_16x16x32_bf16 v[56:59], v[208:211], v[244:247], v[56:59]
    s_waitcnt vmcnt(8)
    v_mfma_f32_16x16x32_bf16 v[60:63], v[212:215], v[244:247], v[60:63]
    s_setprio 1
    s_mov_b32 s66, 0
Lsp_141:
    ds_read_b32 v6, v3 offset:68
    s_add_u32 s66, s66, 1
    s_cmp_gt_u32 s66, 8000000
    s_waitcnt lgkmcnt(0)
    s_cbranch_scc1 Lsd_142
    v_readfirstlane_b32 s11, v6
    s_cmp_ge_u32 s11, 3
    s_cbranch_scc0 Lsp_141
Lsd_142:
    s_mov_b32 s60, 229376
    buffer_load_dwordx4 v[216:219], v4, s[52:55], s60 offen offset:0 sc1
    buffer_load_dwordx4 v[220:223], v4, s[52:55], s60 offen offset:1024 sc1
    buffer_load_dwordx4 v[224:227], v4, s[52:55], s60 offen offset:2048 sc1
    buffer_load_dwordx4 v[228:231], v4, s[52:55], s60 offen offset:3072 sc1
    s_mov_b32 s60, 233472
    buffer_load_dwordx4 v[232:235], v4, s[52:55], s60 offen offset:0 sc1
    buffer_load_dwordx4 v[236:239], v4, s[52:55], s60 offen offset:1024 sc1
    buffer_load_dwordx4 v[240:243], v4, s[52:55], s60 offen offset:2048 sc1
    buffer_load_dwordx4 v[244:247], v4, s[52:55], s60 offen offset:3072 sc1
    s_mov_b32 s66, 0
Lsp_143:
    ds_read_b32 v6, v3 offset:128
    s_add_u32 s66, s66, 1
    s_cmp_gt_u32 s66, 8000000
    s_waitcnt lgkmcnt(0)
    s_cbranch_scc1 Lsd_144
    v_readfirstlane_b32 s11, v6
    s_cmp_ge_u32 s11, 7
    s_cbranch_scc0 Lsp_143
Lsd_144:
    s_waitcnt vmcnt(15)
    v_mfma_f32_16x16x32_bf16 v[16:19], v[100:103], v[64:67], 0
    v_mfma_f32_16x16x32_bf16 v[20:23], v[104:107], v[64:67], 0
    v_mfma_f32_16x16x32_bf16 v[24:27], v[108:111], v[64:67], 0
    v_mfma_f32_16x16x32_bf16 v[28:31], v[112:115], v[64:67], 0
    ds_write_b128 v124, v[48:51] offset:0
    s_waitcnt vmcnt(14)
    v_mfma_f32_16x16x32_bf16 v[16:19], v[116:119], v[68:71], v[16:19]
    v_mfma_f32_16x16x32_bf16 v[20:23], v[120:123], v[68:71], v[20:23]
    v_mfma_f32_16x16x32_bf16 v[24:27], v[32:35], v[68:71], v[24:27]
    v_mfma_f32_16x16x32_bf16 v[28:31], v[36:39], v[68:71], v[28:31]
    v_xor_b32 v8, 64, v124
    ds_write_b128 v8, v[52:55] offset:0
    s_waitcnt vmcnt(13)
    v_mfma_f32_16x16x32_bf16 v[16:19], v[40:43], v[72:75], v[16:19]
    v_mfma_f32_16x16x32_bf16 v[20:23], v[44:47], v[72:75], v[20:23]
    v_mfma_f32_16x16x32_bf16 v[24:27], v[128:131], v[72:75], v[24:27]
    v_mfma_f32_16x16x32_bf16 v[28:31], v[132:135], v[72:75], v[28:31]
    v_xor_b32 v8, 128, v124
    ds_write_b128 v8, v[56:59] offset:0
    s_waitcnt vmcnt(12)
    v_mfma_f32_16x16x32_bf16 v[16:19], v[136:139], v[76:79], v[16:19]
    v_mfma_f32_16x16x32_bf16 v[20:23], v[140:143], v[76:79], v[20:23]
    v_mfma_f32_16x16x32_bf16 v[24:27], v[144:147], v[76:79], v[24:27]
    v_mfma_f32_16x16x32_bf16 v[28:31], v[148:151], v[76:79], v[28:31]
    v_xor_b32 v8, 192, v124
    ds_write_b128 v8, v[60:63] offset:0
    s_waitcnt vmcnt(11)
    v_mfma_f32_16x16x32_bf16 v[16:19], v[152:155], v[80:83], v[16:19]
    v_mfma_f32_16x16x32_bf16 v[20:23], v[156:159], v[80:83], v[20:23]
    v_mfma_f32_16x16x32_bf16 v[24:27], v[160:163], v[80:83], v[24:27]
    v_mfma_f32_16x16x32_bf16 v[28:31], v[164:167], v[80:83], v[28:31]
    s_waitcnt vmcnt(10)
    v_mfma_f32_16x16x32_bf16 v[16:19], v[168:171], v[84:87], v[16:19]
    v_mfma_f32_16x16x32_bf16 v[20:23], v[172:175], v[84:87], v[20:23]
    v_mfma_f32_16x16x32_bf16 v[24:27], v[176:179], v[84:87], v[24:27]
    v_mfma_f32_16x16x32_bf16 v[28:31], v[180:183], v[84:87], v[28:31]
    s_waitcnt vmcnt(9)
    v_mfma_f32_16x16x32_bf16 v[16:19], v[184:187], v[88:91], v[16:19]
    v_mfma_f32_16x16x32_bf16 v[20:23], v[188:191], v[88:91], v[20:23]
    v_mfma_f32_16x16x32_bf16 v[24:27], v[192:195], v[88:91], v[24:27]
    v_mfma_f32_16x16x32_bf16 v[28:31], v[196:199], v[88:91], v[28:31]
    s_waitcnt vmcnt(8)
    v_mfma_f32_16x16x32_bf16 v[16:19], v[200:203], v[92:95], v[16:19]
    v_mfma_f32_16x16x32_bf16 v[20:23], v[204:207], v[92:95], v[20:23]
    v_mfma_f32_16x16x32_bf16 v[24:27], v[208:211], v[92:95], v[24:27]
    v_mfma_f32_16x16x32_bf16 v[28:31], v[212:215], v[92:95], v[28:31]
    ds_read_b32 v10, v3 offset:68
    s_nop 3
    ds_write_b128 v124, v[16:19] offset:32768
    v_xor_b32 v8, 64, v124
    ds_write_b128 v8, v[20:23] offset:32768
    v_xor_b32 v8, 128, v124
    ds_write_b128 v8, v[24:27] offset:32768
    v_xor_b32 v8, 192, v124
    ds_write_b128 v8, v[28:31] offset:32768
    s_mov_b64 exec, 1
    ds_add_rtn_u32 v6, v3, v5 offset:132
    s_mov_b64 exec, -1
    s_setprio 0
    s_mov_b32 s66, 0
Lsp_148:
    ds_read_b32 v6, v3 offset:68
    s_add_u32 s66, s66, 1
    s_cmp_gt_u32 s66, 8000000
    s_waitcnt lgkmcnt(0)
    s_cbranch_scc1 Lsd_149
    v_readfirstlane_b32 s11, v6
    s_cmp_ge_u32 s11, 4
    s_cbranch_scc0 Lsp_148
Lsd_149:
    s_mov_b32 s60, 344064
    buffer_load_dwordx4 v[64:67], v4, s[52:55], s60 offen offset:0 sc1
    buffer_load_dwordx4 v[68:71], v4, s[52:55], s60 offen offset:1024 sc1
    buffer_load_dwordx4 v[72:75], v4, s[52:55], s60 offen offset:2048 sc1
    buffer_load_dwordx4 v[76:79], v4, s[52:55], s60 offen offset:3072 sc1
    s_mov_b32 s60, 348160
    buffer_load_dwordx4 v[80:83], v4, s[52:55], s60 offen offset:0 sc1
    buffer_load_dwordx4 v[84:87], v4, s[52:55], s60 offen offset:1024 sc1
    buffer_load_dwordx4 v[88:91], v4, s[52:55], s60 offen offset:2048 sc1
    buffer_load_dwordx4 v[92:95], v4, s[52:55], s60 offen offset:3072 sc1
    s_waitcnt vmcnt(15)
    v_mfma_f32_16x16x32_bf16 v[48:51], v[100:103], v[216:219], 0
    v_mfma_f32_16x16x32_bf16 v[52:55], v[104:107], v[216:219], 0
    v_mfma_f32_16x16x32_bf16 v[56:59], v[108:111], v[216:219], 0
    v_mfma_f32_16x16x32_bf16 v[60:63], v[112:115], v[216:219], 0
    s_waitcnt vmcnt(14)
    v_mfma_f32_16x16x32_bf16 v[48:51], v[116:119], v[220:223], v[48:51]
    v_mfma_f32_16x16x32_bf16 v[52:55], v[120:123], v[220:223], v[52:55]
    v_mfma_f32_16x16x32_bf16 v[56:59], v[32:35], v[220:223], v[56:59]
    v_mfma_f32_16x16x32_bf16 v[60:63], v[36:39], v[220:223], v[60:63]
    s_waitcnt vmcnt(13)
    v_mfma_f32_16x16x32_bf16 v[48:51], v[40:43], v[224:227], v[48:51]
    v_mfma_f32_16x16x32_bf16 v[52:55], v[44:47], v[224:227], v[52:55]
    v_mfma_f32_16x16x32_bf16 v[56:59], v[128:131], v[224:227], v[56:59]
    v_mfma_f32_16x16x32_bf16 v[60:63], v[132:135], v[224:227], v[60:63]
    s_waitcnt vmcnt(12)
    v_mfma_f32_16x16x32_bf16 v[48:51], v[136:139], v[228:231], v[48:51]
    v_mfma_f32_16x16x32_bf16 v[52:55], v[140:143], v[228:231], v[52:55]
    v_mfma_f32_16x16x32_bf16 v[56:59], v[144:147], v[228:231], v[56:59]
    v_mfma_f32_16x16x32_bf16 v[60:63], v[148:151], v[228:231], v[60:63]
    s_waitcnt vmcnt(11)
    v_mfma_f32_16x16x32_bf16 v[48:51], v[152:155], v[232:235], v[48:51]
    v_mfma_f32_16x16x32_bf16 v[52:55], v[156:159], v[232:235], v[52:55]
    v_mfma_f32_16x16x32_bf16 v[56:59], v[160:163], v[232:235], v[56:59]
    v_mfma_f32_16x16x32_bf16 v[60:63], v[164:167], v[232:235], v[60:63]
    s_waitcnt vmcnt(10)
    v_mfma_f32_16x16x32_bf16 v[48:51], v[168:171], v[236:239], v[48:51]
    v_mfma_f32_16x16x32_bf16 v[52:55], v[172:175], v[236:239], v[52:55]
    v_mfma_f32_16x16x32_bf16 v[56:59], v[176:179], v[236:239], v[56:59]
    v_mfma_f32_16x16x32_bf16 v[60:63], v[180:183], v[236:239], v[60:63]
    s_waitcnt vmcnt(9)
    v_mfma_f32_16x16x32_bf16 v[48:51], v[184:187], v[240:243], v[48:51]
    v_mfma_f32_16x16x32_bf16 v[52:55], v[188:191], v[240:243], v[52:55]
    v_mfma_f32_16x16x32_bf16 v[56:59], v[192:195], v[240:243], v[56:59]
    v_mfma_f32_16x16x32_bf16 v[60:63], v[196:199], v[240:243], v[60:63]
    s_waitcnt vmcnt(8)
    v_mfma_f32_16x16x32_bf16 v[48:51], v[200:203], v[244:247], v[48:51]
    v_mfma_f32_16x16x32_bf16 v[52:55], v[204:207], v[244:247], v[52:55]
    v_mfma_f32_16x16x32_bf16 v[56:59], v[208:211], v[244:247], v[56:59]
    v_mfma_f32_16x16x32_bf16 v[60:63], v[212:215], v[244:247], v[60:63]
    s_mov_b32 s66, 0
Lsp_150:
    ds_read_b32 v6, v3 offset:132
    s_add_u32 s66, s66, 1
    s_cmp_gt_u32 s66, 8000000
    s_waitcnt lgkmcnt(0)
    s_cbranch_scc1 Lsd_151
    v_readfirstlane_b32 s11, v6
    s_cmp_ge_u32 s11, 7
    s_cbranch_scc0 Lsp_150
Lsd_151:
    s_cmp_lt_u32 s3, 4
    s_cbranch_scc0 Lrd_152
    v_add_u32 v8, 0x0, v125
    v_add_u32 v15, 0x20000, v125
    ds_read_b128 v[216:219], v8 offset:0
    ds_read_b128 v[220:223], v8 offset:4096
    ds_read_b128 v[224:227], v8 offset:8192
    ds_read_b128 v[228:231], v8 offset:12288
    ds_read_b128 v[232:235], v8 offset:16384
    ds_read_b128 v[236:239], v8 offset:20480
    ds_read2_b32 v[240:241], v127 offset0:64 offset1:66
    ds_read2_b32 v[242:243], v127 offset0:68 offset1:70
    ds_read_b128 v[244:247], v15
    s_waitcnt lgkmcnt(7)
    v_pk_add_f32 v[216:217], v[216:217], v[220:221]
    v_pk_add_f32 v[218:219], v[218:219], v[222:223]
    ds_read_b128 v[220:223], v8 offset:24576
    s_waitcnt lgkmcnt(6)
    v_pk_add_f32 v[224:225], v[224:225], v[228:229]
    v_pk_add_f32 v[226:227], v[226:227], v[230:231]
    s_waitcnt lgkmcnt(4)
    v_pk_add_f32 v[232:233], v[232:233], v[236:237]
    v_pk_add_f32 v[234:235], v[234:235], v[238:239]
    v_pk_add_f32 v[216:217], v[216:217], v[224:225]
    v_pk_add_f32 v[218:219], v[218:219], v[226:227]
    s_waitcnt lgkmcnt(0)
    v_pk_add_f32 v[232:233], v[232:233], v[220:221]
    v_pk_add_f32 v[234:235], v[234:235], v[222:223]
    v_pk_add_f32 v[216:217], v[216:217], v[232:233]
    v_pk_add_f32 v[218:219], v[218:219], v[234:235]
    v_pk_fma_f32 v[216:217], v[216:217], v[240:241], v[244:245]
    v_pk_fma_f32 v[218:219], v[218:219], v[242:243], v[246:247]
    s_nop 1
    v_permlane32_swap_b32 v216, v218
    v_permlane32_swap_b32 v217, v219
    v_cvt_pk_bf16_f32 v220, v216, v218
    v_cvt_pk_bf16_f32 v221, v217, v219
    s_add_u32 s60, s88, 0
    buffer_store_dwordx2 v[220:221], v126, s[44:47], s60 offen
Lrd_152:
    s_cmp_lt_u32 s3, 4
    s_cbranch_scc1 Lrd_153
    v_add_u32 v8, 0x8000, v125
    v_add_u32 v15, 0x21000, v125
    ds_read_b128 v[216:219], v8 offset:0
    ds_read_b128 v[220:223], v8 offset:4096
    ds_read_b128 v[224:227], v8 offset:8192
    ds_read_b128 v[228:231], v8 offset:12288
    ds_read_b128 v[232:235], v8 offset:16384
    ds_read_b128 v[236:239], v8 offset:20480
    ds_read2_b32 v[240:241], v127 offset0:64 offset1:66
    ds_read2_b32 v[242:243], v127 offset0:68 offset1:70
    ds_read_b128 v[244:247], v15
    s_waitcnt lgkmcnt(7)
    v_pk_add_f32 v[216:217], v[216:217], v[220:221]
    v_pk_add_f32 v[218:219], v[218:219], v[222:223]
    ds_read_b128 v[220:223], v8 offset:24576
    s_waitcnt lgkmcnt(6)
    v_pk_add_f32 v[224:225], v[224:225], v[228:229]
    v_pk_add_f32 v[226:227], v[226:227], v[230:231]
    s_waitcnt lgkmcnt(4)
    v_pk_add_f32 v[232:233], v[232:233], v[236:237]
    v_pk_add_f32 v[234:235], v[234:235], v[238:239]
    v_pk_add_f32 v[216:217], v[216:217], v[224:225]
    v_pk_add_f32 v[218:219], v[218:219], v[226:227]
    s_waitcnt lgkmcnt(0)
    v_pk_add_f32 v[232:233], v[232:233], v[220:221]
    v_pk_add_f32 v[234:235], v[234:235], v[222:223]
    v_pk_add_f32 v[216:217], v[216:217], v[232:233]
    v_pk_add_f32 v[218:219], v[218:219], v[234:235]
    v_pk_fma_f32 v[216:217], v[216:217], v[240:241], v[244:245]
    v_pk_fma_f32 v[218:219], v[218:219], v[242:243], v[246:247]
    s_nop 1
    v_permlane32_swap_b32 v216, v218
    v_permlane32_swap_b32 v217, v219
    v_cvt_pk_bf16_f32 v220, v216, v218
    v_cvt_pk_bf16_f32 v221, v217, v219
    s_add_u32 s60, s88, 32768
    buffer_store_dwordx2 v[220:221], v126, s[44:47], s60 offen
Lrd_153:
Lpx_147:
    s_waitcnt vmcnt(7)
    v_mfma_f32_16x16x32_bf16 v[16:19], v[100:103], v[64:67], 0
    v_mfma_f32_16x16x32_bf16 v[20:23], v[104:107], v[64:67], 0
    v_mfma_f32_16x16x32_bf16 v[24:27], v[108:111], v[64:67], 0
    v_mfma_f32_16x16x32_bf16 v[28:31], v[112:115], v[64:67], 0
    v_add_u32 v124, 0x10000, v124
    ds_write_b128 v124, v[48:51] offset:0
    s_waitcnt vmcnt(6)
    v_mfma_f32_16x16x32_bf16 v[16:19], v[116:119], v[68:71], v[16:19]
    v_mfma_f32_16x16x32_bf16 v[20:23], v[120:123], v[68:71], v[20:23]
    v_mfma_f32_16x16x32_bf16 v[24:27], v[32:35], v[68:71], v[24:27]
    v_mfma_f32_16x16x32_bf16 v[28:31], v[36:39], v[68:71], v[28:31]
    v_xor_b32 v8, 64, v124
    ds_write_b128 v8, v[52:55] offset:0
    s_waitcnt vmcnt(5)
    v_mfma_f32_16x16x32_bf16 v[16:19], v[40:43], v[72:75], v[16:19]
    v_mfma_f32_16x16x32_bf16 v[20:23], v[44:47], v[72:75], v[20:23]
    v_mfma_f32_16x16x32_bf16 v[24:27], v[128:131], v[72:75], v[24:27]
    v_mfma_f32_16x16x32_bf16 v[28:31], v[132:135], v[72:75], v[28:31]
    v_xor_b32 v8, 128, v124
    ds_write_b128 v8, v[56:59] offset:0
    s_waitcnt vmcnt(4)
    v_mfma_f32_16x16x32_bf16 v[16:19], v[136:139], v[76:79], v[16:19]
    v_mfma_f32_16x16x32_bf16 v[20:23], v[140:143], v[76:79], v[20:23]
    v_mfma_f32_16x16x32_bf16 v[24:27], v[144:147], v[76:79], v[24:27]
    v_mfma_f32_16x16x32_bf16 v[28:31], v[148:151], v[76:79], v[28:31]
    v_xor_b32 v8, 192, v124
    ds_write_b128 v8, v[60:63] offset:0
    s_waitcnt vmcnt(3)
    v_mfma_f32_16x16x32_bf16 v[16:19], v[152:155], v[80:83], v[16:19]
    v_mfma_f32_16x16x32_bf16 v[20:23], v[156:159], v[80:83], v[20:23]
    v_mfma_f32_16x16x32_bf16 v[24:27], v[160:163], v[80:83], v[24:27]
    v_mfma_f32_16x16x32_bf16 v[28:31], v[164:167], v[80:83], v[28:31]
    s_waitcnt vmcnt(2)
    v_mfma_f32_16x16x32_bf16 v[16:19], v[168:171], v[84:87], v[16:19]
    v_mfma_f32_16x16x32_bf16 v[20:23], v[172:175], v[84:87], v[20:23]
    v_mfma_f32_16x16x32_bf16 v[24:27], v[176:179], v[84:87], v[24:27]
    v_mfma_f32_16x16x32_bf16 v[28:31], v[180:183], v[84:87], v[28:31]
    s_waitcnt vmcnt(1)
    v_mfma_f32_16x16x32_bf16 v[16:19], v[184:187], v[88:91], v[16:19]
    v_mfma_f32_16x16x32_bf16 v[20:23], v[188:191], v[88:91], v[20:23]
    v_mfma_f32_16x16x32_bf16 v[24:27], v[192:195], v[88:91], v[24:27]
    v_mfma_f32_16x16x32_bf16 v[28:31], v[196:199], v[88:91], v[28:31]
    s_waitcnt vmcnt(0)
    v_mfma_f32_16x16x32_bf16 v[16:19], v[200:203], v[92:95], v[16:19]
    v_mfma_f32_16x16x32_bf16 v[20:23], v[204:207], v[92:95], v[20:23]
    v_mfma_f32_16x16x32_bf16 v[24:27], v[208:211], v[92:95], v[24:27]
    v_mfma_f32_16x16x32_bf16 v[28:31], v[212:215], v[92:95], v[28:31]
    s_nop 4
    ds_write_b128 v124, v[16:19] offset:32768
    v_xor_b32 v8, 64, v124
    ds_write_b128 v8, v[20:23] offset:32768
    v_xor_b32 v8, 128, v124
    ds_write_b128 v8, v[24:27] offset:32768
    v_xor_b32 v8, 192, v124
    ds_write_b128 v8, v[28:31] offset:32768
    s_waitcnt lgkmcnt(0)
L_fin:
    s_barrier
    s_cmp_lt_u32 s3, 4
    s_cbranch_scc0 Lrd_154
    v_add_u32 v8, 0x10000, v125
    v_add_u32 v15, 0x22000, v125
    ds_read_b128 v[216:219], v8 offset:0
    ds_read_b128 v[220:223], v8 offset:4096
    ds_read_b128 v[224:227], v8 offset:8192
    ds_read_b128 v[228:231], v8 offset:12288
    ds_read_b128 v[232:235], v8 offset:16384
    ds_read_b128 v[236:239], v8 offset:20480
    ds_read2_b32 v[240:241], v127 offset0:64 offset1:66
    ds_read2_b32 v[242:243], v127 offset0:68 offset1:70
    ds_read_b128 v[244:247], v15
    s_waitcnt lgkmcnt(7)
    v_pk_add_f32 v[216:217], v[216:217], v[220:221]
    v_pk_add_f32 v[218:219], v[218:219], v[222:223]
    ds_read_b128 v[220:223], v8 offset:24576
    s_waitcnt lgkmcnt(6)
    v_pk_add_f32 v[224:225], v[224:225], v[228:229]
    v_pk_add_f32 v[226:227], v[226:227], v[230:231]
    s_waitcnt lgkmcnt(4)
    v_pk_add_f32 v[232:233], v[232:233], v[236:237]
    v_pk_add_f32 v[234:235], v[234:235], v[238:239]
    v_pk_add_f32 v[216:217], v[216:217], v[224:225]
    v_pk_add_f32 v[218:219], v[218:219], v[226:227]
    s_waitcnt lgkmcnt(0)
    v_pk_add_f32 v[232:233], v[232:233], v[220:221]
    v_pk_add_f32 v[234:235], v[234:235], v[222:223]
    v_pk_add_f32 v[216:217], v[216:217], v[232:233]
    v_pk_add_f32 v[218:219], v[218:219], v[234:235]
    v_pk_fma_f32 v[216:217], v[216:217], v[240:241], v[244:245]
    v_pk_fma_f32 v[218:219], v[218:219], v[242:243], v[246:247]
    s_nop 1
    v_permlane32_swap_b32 v216, v218
    v_permlane32_swap_b32 v217, v219
    v_cvt_pk_bf16_f32 v220, v216, v218
    v_cvt_pk_bf16_f32 v221, v217, v219
    s_add_u32 s60, s88, 65536
    buffer_store_dwordx2 v[220:221], v126, s[44:47], s60 offen
Lrd_154:
    s_cmp_lt_u32 s3, 4
    s_cbranch_scc1 Lrd_155
    v_add_u32 v8, 0x18000, v125
    v_add_u32 v15, 0x23000, v125
    ds_read_b128 v[216:219], v8 offset:0
    ds_read_b128 v[220:223], v8 offset:4096
    ds_read_b128 v[224:227], v8 offset:8192
    ds_read_b128 v[228:231], v8 offset:12288
    ds_read_b128 v[232:235], v8 offset:16384
    ds_read_b128 v[236:239], v8 offset:20480
    ds_read2_b32 v[240:241], v127 offset0:64 offset1:66
    ds_read2_b32 v[242:243], v127 offset0:68 offset1:70
    ds_read_b128 v[244:247], v15
    s_waitcnt lgkmcnt(7)
    v_pk_add_f32 v[216:217], v[216:217], v[220:221]
    v_pk_add_f32 v[218:219], v[218:219], v[222:223]
    ds_read_b128 v[220:223], v8 offset:24576
    s_waitcnt lgkmcnt(6)
    v_pk_add_f32 v[224:225], v[224:225], v[228:229]
    v_pk_add_f32 v[226:227], v[226:227], v[230:231]
    s_waitcnt lgkmcnt(4)
    v_pk_add_f32 v[232:233], v[232:233], v[236:237]
    v_pk_add_f32 v[234:235], v[234:235], v[238:239]
    v_pk_add_f32 v[216:217], v[216:217], v[224:225]
    v_pk_add_f32 v[218:219], v[218:219], v[226:227]
    s_waitcnt lgkmcnt(0)
    v_pk_add_f32 v[232:233], v[232:233], v[220:221]
    v_pk_add_f32 v[234:235], v[234:235], v[222:223]
    v_pk_add_f32 v[216:217], v[216:217], v[232:233]
    v_pk_add_f32 v[218:219], v[218:219], v[234:235]
    v_pk_fma_f32 v[216:217], v[216:217], v[240:241], v[244:245]
    v_pk_fma_f32 v[218:219], v[218:219], v[242:243], v[246:247]
    s_nop 1
    v_permlane32_swap_b32 v216, v218
    v_permlane32_swap_b32 v217, v219
    v_cvt_pk_bf16_f32 v220, v216, v218
    v_cvt_pk_bf16_f32 v221, v217, v219
    s_add_u32 s60, s88, 98304
    buffer_store_dwordx2 v[220:221], v126, s[44:47], s60 offen
Lrd_155:
L_end:
    s_endpgm
.section .rodata,"a"
.p2align 6
.amdhsa_kernel adaLN_cond__ssm_conv_h3__geglu_ffn__prompt_kernel
  .amdhsa_next_free_vgpr 256
  .amdhsa_next_free_sgpr 102
  .amdhsa_accum_offset 256
  .amdhsa_group_segment_fixed_size 0
  .amdhsa_kernarg_size 120
  .amdhsa_user_sgpr_count 2
  .amdhsa_user_sgpr_kernarg_segment_ptr 1
  .amdhsa_system_sgpr_workgroup_id_x 1
  .amdhsa_float_denorm_mode_32 3
.end_amdhsa_kernel
```
